```python
import torch

def _softmax(x, axis=-1):
    return torch.softmax(x, dim=axis)
def _gelu(x):
    return torch.nn.functional.gelu(x, approximate="tanh")
def _silu(x):
    return torch.nn.functional.silu(x)
def _sigmoid(x):
    return torch.sigmoid(x)
def _layernorm(x, axis=-1, eps=1e-5):
    m = x.mean(dim=axis, keepdim=True)
    v = x.var(dim=axis, keepdim=True, unbiased=False)
    return (x - m) / torch.sqrt(v + eps)
def _scatter_add(tgt, idx, src, axis=0):
    return tgt.clone().index_add_(axis, idx, src)
def _segment_sum(src, seg, n):
    out = torch.zeros((n,) + src.shape[1:], dtype=src.dtype)
    return out.index_add_(0, seg, src)
def _pad(x, pw):
    flat = tuple(v for pair in reversed(pw) for v in pair)
    return torch.nn.functional.pad(x, flat)

kernel_name = 'standalone__low_rank_proj_linformer__sampling'

def setup_inputs():

    _w = (lambda a: (lambda t: t.to(torch.bfloat16) if t.is_floating_point() else t)(torch.as_tensor(a)))
    B, H, Sq, Skv, Dh, R = 16, 32, 4, 4096, 128, 16
    return {
        "q": _w((lambda *s: torch.randn(*s, dtype=torch.bfloat16) * 0.8)(B, H, Sq, Dh)),
        "k": _w((lambda *s: torch.randn(*s, dtype=torch.bfloat16) * 0.8)(B, H, Skv, Dh)),
        "v": _w((lambda *s: torch.randn(*s, dtype=torch.bfloat16) * 0.05)(B, H, Skv, Dh)),
        "e_proj": _w((lambda *s: torch.randn(*s, dtype=torch.bfloat16) * 0.8)(R, Skv) * (Skv ** -0.5)),
        "f_proj": _w((lambda *s: torch.randn(*s, dtype=torch.bfloat16) * 0.05)(R, Skv) * (Skv ** -0.5)),
    }

def reference(q, k, v, e_proj, f_proj):
    B, H, Sq, Dh = q.shape
    kp = torch.einsum("rn,bhnd->bhrd", e_proj, k)
    vp = torch.einsum("rn,bhnd->bhrd", f_proj, v)
    scores = torch.einsum("bhqd,bhrd->bhqr", q, kp) * (Dh ** -0.5)
    p = _softmax(scores, axis=-1)
    o = torch.einsum("bhqr,bhrd->bhqd", p, vp)
    return o
```

```asm
; @launch grid=(256,1,1) block=(64,1,1) lds=149760
.amdgcn_target "amdgcn-amd-amdhsa--gfx950"
.text
.globl standalone__low_rank_proj_linformer__sampling_kernel
.p2align 8
.type standalone__low_rank_proj_linformer__sampling_kernel,@function
standalone__low_rank_proj_linformer__sampling_kernel:
    s_cmp_ge_u32 s2, 256
    s_cbranch_scc1 L_end
    s_load_dwordx16 s[4:19], s[0:1], 0
    s_mov_b32 s3, s2
    s_bitcmp1_b32 s3, 6
    s_cselect_b32 s41, 4, 0
    s_xor_b32 s2, s2, s41
    s_bitcmp1_b32 s3, 7
    s_cselect_b32 s41, 2, 0
    s_xor_b32 s2, s2, s41
    s_getpc_b64 s[72:73]
L_pc:
    v_lshlrev_b32 v10, 7, v0
    s_bfe_u32 s41, s3, 0x20003
    s_lshl_b32 s41, s41, 13
    s_min_u32 s41, s41, L_end-L_pc-8064
    v_add_u32 v10, s41, v10
    v_mov_b32 v11, s73
    v_add_co_u32 v10, vcc, s72, v10
    s_nop 1
    v_addc_co_u32 v11, vcc, 0, v11, vcc
    global_load_dword v255, v[10:11], off
    v_lshlrev_b32 v1, 4, v0
    s_lshl_b32 s36, s2, 21
    s_add_u32 s37, s36, 32768
    s_mov_b32 s22, 0x20000000
    s_mov_b32 s23, 0x20000
    s_mov_b32 s26, 0x20000
    s_mov_b32 s27, 0x20000
    s_mov_b32 s46, 0
    s_mov_b32 m0, 0
    s_waitcnt lgkmcnt(0)
    s_mov_b32 s20, s6
    s_mov_b32 s21, s7
    s_mov_b32 s24, s10
    s_mov_b32 s25, s11
    buffer_load_dwordx4 v[96:99], v1, s[20:23], s36 offen nt
    buffer_load_dwordx4 v[100:103], v1, s[20:23], s36 offen offset:1024 nt
    buffer_load_dwordx4 v[104:107], v1, s[20:23], s36 offen offset:2048 nt
    buffer_load_dwordx4 v[108:111], v1, s[20:23], s36 offen offset:3072 nt
    s_add_u32 s36, s36, 4096
    buffer_load_dwordx4 v[112:115], v1, s[20:23], s37 offen nt
    buffer_load_dwordx4 v[116:119], v1, s[20:23], s37 offen offset:1024 nt
    buffer_load_dwordx4 v[120:123], v1, s[20:23], s37 offen offset:2048 nt
    buffer_load_dwordx4 v[124:127], v1, s[20:23], s37 offen offset:3072 nt
    s_add_u32 s37, s37, 4096
    buffer_load_dwordx4 v1, s[24:27], s46 offen lds
    s_add_u32 m0, m0, 9232
    s_add_u32 s46, s46, 8192
    buffer_load_dwordx4 v1, s[24:27], s46 offen lds
    s_add_u32 m0, m0, 9232
    s_add_u32 s46, s46, 8192
    buffer_load_dwordx4 v1, s[24:27], s46 offen lds
    s_add_u32 m0, m0, 9232
    s_add_u32 s46, s46, 8192
    buffer_load_dwordx4 v1, s[24:27], s46 offen lds
    s_add_u32 m0, m0, 9232
    s_add_u32 s46, s46, 8192
    buffer_load_dwordx4 v1, s[24:27], s46 offen lds
    s_add_u32 m0, m0, 9232
    s_add_u32 s46, s46, 8192
    buffer_load_dwordx4 v1, s[24:27], s46 offen lds
    s_add_u32 m0, m0, 9232
    s_add_u32 s46, s46, 8192
    buffer_load_dwordx4 v1, s[24:27], s46 offen lds
    s_add_u32 m0, m0, 9232
    s_add_u32 s46, s46, 8192
    buffer_load_dwordx4 v1, s[24:27], s46 offen lds
    s_add_u32 m0, m0, 9232
    s_add_u32 s46, s46, 8192
    buffer_load_dwordx4 v1, s[24:27], s46 offen lds
    s_add_u32 m0, m0, 9232
    s_add_u32 s46, s46, 8192
    buffer_load_dwordx4 v1, s[24:27], s46 offen lds
    s_add_u32 m0, m0, 9232
    s_add_u32 s46, s46, 8192
    buffer_load_dwordx4 v1, s[24:27], s46 offen lds
    s_add_u32 m0, m0, 9232
    s_add_u32 s46, s46, 8192
    buffer_load_dwordx4 v1, s[24:27], s46 offen lds
    s_add_u32 m0, m0, 9232
    s_add_u32 s46, s46, 8192
    buffer_load_dwordx4 v1, s[24:27], s46 offen lds
    s_add_u32 m0, m0, 9232
    s_add_u32 s46, s46, 8192
    buffer_load_dwordx4 v1, s[24:27], s46 offen lds
    s_add_u32 m0, m0, 9232
    s_add_u32 s46, s46, 8192
    buffer_load_dwordx4 v1, s[24:27], s46 offen lds
    s_add_u32 m0, m0, 9232
    s_add_u32 s46, s46, 8192
    buffer_load_dwordx4 v1, s[24:27], s46 offen lds
    s_mov_b32 m0, 1024
    s_mov_b32 s46, 1024
    buffer_load_dwordx4 v[128:131], v1, s[20:23], s36 offen nt
    buffer_load_dwordx4 v[132:135], v1, s[20:23], s36 offen offset:1024 nt
    buffer_load_dwordx4 v[136:139], v1, s[20:23], s36 offen offset:2048 nt
    buffer_load_dwordx4 v[140:143], v1, s[20:23], s36 offen offset:3072 nt
    s_add_u32 s36, s36, 4096
    buffer_load_dwordx4 v[144:147], v1, s[20:23], s37 offen nt
    buffer_load_dwordx4 v[148:151], v1, s[20:23], s37 offen offset:1024 nt
    buffer_load_dwordx4 v[152:155], v1, s[20:23], s37 offen offset:2048 nt
    buffer_load_dwordx4 v[156:159], v1, s[20:23], s37 offen offset:3072 nt
    s_add_u32 s37, s37, 4096
    buffer_load_dwordx4 v[160:163], v1, s[20:23], s36 offen nt
    buffer_load_dwordx4 v[164:167], v1, s[20:23], s36 offen offset:1024 nt
    buffer_load_dwordx4 v[168:171], v1, s[20:23], s36 offen offset:2048 nt
    buffer_load_dwordx4 v[172:175], v1, s[20:23], s36 offen offset:3072 nt
    s_add_u32 s36, s36, 4096
    buffer_load_dwordx4 v1, s[24:27], s46 offen lds
    s_add_u32 m0, m0, 9232
    s_add_u32 s46, s46, 8192
    buffer_load_dwordx4 v1, s[24:27], s46 offen lds
    s_add_u32 m0, m0, 9232
    s_add_u32 s46, s46, 8192
    buffer_load_dwordx4 v1, s[24:27], s46 offen lds
    s_add_u32 m0, m0, 9232
    s_add_u32 s46, s46, 8192
    buffer_load_dwordx4 v1, s[24:27], s46 offen lds
    s_add_u32 m0, m0, 9232
    s_add_u32 s46, s46, 8192
    s_lshr_b32 s41, s3, 3
    s_lshl_b32 s41, s41, 12
    buffer_load_dwordx4 a[0:3], v1, s[24:27], s41 offen
    buffer_load_dwordx4 a[4:7], v1, s[24:27], s41 offen offset:1024
    buffer_load_dwordx4 a[8:11], v1, s[24:27], s41 offen offset:2048
    buffer_load_dwordx4 a[12:15], v1, s[24:27], s41 offen offset:3072
    s_mov_b32 s42, m0
    s_lshl_b32 s41, s2, 11
    s_mov_b32 m0, 147712
    s_add_u32 s56, s4, s41
    s_addc_u32 s57, s5, 0
    s_mov_b32 s58, 0x800
    s_mov_b32 s59, 0x20000
    s_mov_b32 m0, s42
    s_add_u32 s28, s14, s41
    s_addc_u32 s29, s15, 0
    s_mov_b32 s30, 0x800
    s_mov_b32 s31, 0x20000
    v_and_b32 v20, 15, v0
    v_lshrrev_b32 v21, 4, v0
    v_mul_u32_u24 v4, 9232, v20
    v_bfe_u32 v2, v0, 4, 1
    v_lshl_add_u32 v4, v2, 4, v4
    v_lshrrev_b32 v2, 5, v0
    v_lshl_add_u32 v4, v2, 8, v4
    v_mov_b32 v2, v4
    v_lshrrev_b32 v3, 2, v20
    v_lshlrev_b32 v3, 8, v3
    v_lshl_add_u32 v3, v21, 6, v3
    v_add_u32 v3, 147712, v3
    s_mov_b32 s39, 0x05040100
    s_mov_b32 s40, 0x07060302
    s_mov_b32 s43, 0x3db504f3
    s_mov_b32 s44, 0x3fb8aa3b
    s_mov_b32 s60, s16
    s_mov_b32 s61, s17
    s_mov_b32 s62, 0x40
    s_mov_b32 s63, 0x20000
    s_getreg_b32 s41, hwreg(HW_REG_HW_ID, 8, 4)
    s_getreg_b32 s42, hwreg(HW_REG_HW_ID, 13, 2)
    s_getreg_b32 s65, hwreg(HW_REG_XCC_ID, 0, 3)
    s_lshl_b32 s42, s42, 4
    s_or_b32 s64, s41, s42
    s_bitcmp1_b32 s65, 0
    s_cselect_b32 s67, 24, 20
    v_mov_b32 v5, 1
    s_mov_b32 s52, 1
    v_mov_b32 v64, 0
    v_mov_b32 v65, 0
    v_mov_b32 v66, 0
    v_mov_b32 v67, 0
    v_mov_b32 v68, 0
    v_mov_b32 v69, 0
    v_mov_b32 v70, 0
    v_mov_b32 v71, 0
    v_mov_b32 v72, 0
    v_mov_b32 v73, 0
    v_mov_b32 v74, 0
    v_mov_b32 v75, 0
    v_mov_b32 v76, 0
    v_mov_b32 v77, 0
    v_mov_b32 v78, 0
    v_mov_b32 v79, 0
    v_mov_b32 v80, 0
    v_mov_b32 v81, 0
    v_mov_b32 v82, 0
    v_mov_b32 v83, 0
    v_mov_b32 v84, 0
    v_mov_b32 v85, 0
    v_mov_b32 v86, 0
    v_mov_b32 v87, 0
    v_mov_b32 v88, 0
    v_mov_b32 v89, 0
    v_mov_b32 v90, 0
    v_mov_b32 v91, 0
    v_mov_b32 v92, 0
    v_mov_b32 v93, 0
    v_mov_b32 v94, 0
    v_mov_b32 v95, 0
    v_mov_b32 v48, 0
    v_mov_b32 v49, 0
    v_mov_b32 v50, 0
    v_mov_b32 v51, 0
    v_mov_b32 v52, 0
    v_mov_b32 v53, 0
    v_mov_b32 v54, 0
    v_mov_b32 v55, 0
    v_mov_b32 v56, 0
    v_mov_b32 v57, 0
    v_mov_b32 v58, 0
    v_mov_b32 v59, 0
    v_mov_b32 v60, 0
    v_mov_b32 v61, 0
    v_mov_b32 v62, 0
    v_mov_b32 v63, 0
    v_mov_b32 v12, 0
    v_mov_b32 v13, 0
    v_mov_b32 v14, 0
    v_mov_b32 v15, 0
    s_waitcnt vmcnt(43)
    buffer_load_dwordx4 v[176:179], v1, s[20:23], s37 offen nt
    s_waitcnt vmcnt(43)
    buffer_load_dwordx4 v[180:183], v1, s[20:23], s37 offen offset:1024 nt
    s_waitcnt vmcnt(43)
    buffer_load_dwordx4 v[184:187], v1, s[20:23], s37 offen offset:2048 nt
    s_waitcnt vmcnt(43)
    buffer_load_dwordx4 v[188:191], v1, s[20:23], s37 offen offset:3072 nt
    s_add_u32 s37, s37, 4096
    s_waitcnt vmcnt(43)
    buffer_load_dwordx4 v[192:195], v1, s[20:23], s36 offen nt
    s_waitcnt vmcnt(43)
    buffer_load_dwordx4 v[196:199], v1, s[20:23], s36 offen offset:1024 nt
    s_waitcnt vmcnt(43)
    buffer_load_dwordx4 v[200:203], v1, s[20:23], s36 offen offset:2048 nt
    s_waitcnt vmcnt(43)
    buffer_load_dwordx4 v[204:207], v1, s[20:23], s36 offen offset:3072 nt
    s_add_u32 s36, s36, 4096
    s_and_b32 s41, s36, 32767
    s_cmp_eq_u32 s41, 0
    s_cselect_b32 s41, 32768, 0
    s_add_u32 s36, s36, s41
    s_waitcnt vmcnt(27)
    buffer_load_dwordx4 v[208:211], v1, s[20:23], s37 offen nt
    s_waitcnt vmcnt(27)
    buffer_load_dwordx4 v[212:215], v1, s[20:23], s37 offen offset:1024 nt
    ds_read_b128 v[16:19], v2
    s_mov_b32 s47, 0
    s_mov_b32 s45, 5
    s_mov_b32 s38, 32
L_k:
    s_cmp_eq_u32 s38, s45
    s_cbranch_scc0 L_nf
    s_mov_b32 m0, 147712
    s_mov_b32 s24, s12
    s_mov_b32 s25, s13
    buffer_load_dwordx4 v1, s[56:59], 0 offen nt lds
    buffer_load_dwordx4 v1, s[56:59], 0 offen offset:1024 nt lds
    s_mov_b32 s46, 0
    s_mov_b32 m0, 8192
    s_lshr_b32 s41, s3, 3
    s_lshl_b32 s41, s41, 12
    buffer_load_dwordx4 a[0:3], v1, s[24:27], s41 offen
    buffer_load_dwordx4 a[4:7], v1, s[24:27], s41 offen offset:1024
    buffer_load_dwordx4 a[8:11], v1, s[24:27], s41 offen offset:2048
    buffer_load_dwordx4 a[12:15], v1, s[24:27], s41 offen offset:3072
L_nf:
    s_cmp_gt_u32 s38, s45
    s_cselect_b64 vcc, -1, 0
    s_waitcnt vmcnt(23)
    v_cmp_le_u32 s[54:55], s52, v5
    s_nop 0
    s_bcnt1_i32_b64 s41, s[54:55]
    s_cmp_ge_u32 s41, s67
    s_cbranch_scc1 L_km1
L_km0:
    s_waitcnt vmcnt(22)
    buffer_load_dwordx4 v[216:219], v1, s[20:23], s37 offen offset:2048 nt
    v_mfma_f32_16x16x32_bf16 v[80:83], v[48:51], v[12:15], v[80:83]
    v_perm_b32 v32, v100, v96, s39
    v_mfma_f32_16x16x32_bf16 v[84:87], v[52:55], v[12:15], v[84:87]
    v_perm_b32 v36, v100, v96, s40
    v_mfma_f32_16x16x32_bf16 v[88:91], v[56:59], v[12:15], v[88:91]
    v_perm_b32 v40, v101, v97, s39
    v_mfma_f32_16x16x32_bf16 v[92:95], v[60:63], v[12:15], v[92:95]
    v_perm_b32 v44, v101, v97, s40
    s_waitcnt vmcnt(22)
    buffer_load_dwordx4 v[220:223], v1, s[20:23], s37 offen offset:3072 nt
    s_add_u32 s37, s37, 4096
    s_and_b32 s41, s37, 32767
    s_cmp_eq_u32 s41, 0
    s_cselect_b32 s41, 32768, 0
    s_add_u32 s37, s37, s41
    s_add_u32 s41, s38, s47
    s_cmp_eq_u32 s41, 8193
    s_cbranch_scc0 L_k0_0_ns
    s_mov_b32 s20, s8
    s_mov_b32 s21, s9
    s_lshl_b32 s36, s2, 21
    s_add_u32 s37, s36, 32768
L_k0_0_ns:
    v_perm_b32 v48, v102, v98, s39
    v_perm_b32 v52, v102, v98, s40
    v_perm_b32 v56, v103, v99, s39
    v_perm_b32 v60, v103, v99, s40
    s_cbranch_vccz L_k0_0_np
    s_waitcnt vmcnt(22)
    buffer_load_dwordx4 v1, s[24:27], s46 offen lds
    s_add_u32 s46, s46, 8192
    s_add_u32 m0, m0, 9232
L_k0_0_np:
    s_waitcnt vmcnt(22)
    buffer_load_dwordx4 v[96:99], v1, s[20:23], s36 offen nt
    v_perm_b32 v33, v108, v104, s39
    v_perm_b32 v37, v108, v104, s40
    v_perm_b32 v41, v109, v105, s39
    v_perm_b32 v45, v109, v105, s40
    s_waitcnt vmcnt(22)
    buffer_load_dwordx4 v[100:103], v1, s[20:23], s36 offen offset:1024 nt
    v_perm_b32 v49, v110, v106, s39
    v_perm_b32 v53, v110, v106, s40
    v_perm_b32 v57, v111, v107, s39
    v_perm_b32 v61, v111, v107, s40
    s_waitcnt lgkmcnt(0)
    v_perm_b32 v12, v18, v16, s39
    v_perm_b32 v14, v19, v17, s39
    v_perm_b32 v13, v18, v16, s40
    v_perm_b32 v15, v19, v17, s40
    v_permlane32_swap_b32 v12, v14
    v_add_u32 v2, 32, v2
    v_permlane32_swap_b32 v13, v15
    ds_read_b128 v[16:19], v2
    s_waitcnt vmcnt(22)
    buffer_load_dwordx4 v[104:107], v1, s[20:23], s36 offen offset:2048 nt
    v_perm_b32 v34, v116, v112, s39
    v_perm_b32 v38, v116, v112, s40
    v_perm_b32 v42, v117, v113, s39
    v_perm_b32 v46, v117, v113, s40
    v_permlane16_swap_b32 v12, v13
    v_permlane16_swap_b32 v14, v15
    s_waitcnt vmcnt(22)
    buffer_load_dwordx4 v[108:111], v1, s[20:23], s36 offen offset:3072 nt
    s_add_u32 s36, s36, 4096
    v_perm_b32 v50, v118, v114, s39
    v_perm_b32 v54, v118, v114, s40
    v_perm_b32 v58, v119, v115, s39
    v_perm_b32 v62, v119, v115, s40
    s_waitcnt vmcnt(22)
    buffer_load_dwordx4 v[112:115], v1, s[20:23], s37 offen nt
    v_perm_b32 v35, v124, v120, s39
    v_perm_b32 v39, v124, v120, s40
    v_perm_b32 v43, v125, v121, s39
    v_perm_b32 v47, v125, v121, s40
    s_waitcnt vmcnt(22)
    buffer_load_dwordx4 v[116:119], v1, s[20:23], s37 offen offset:1024 nt
    v_mfma_f32_16x16x32_bf16 v[64:67], v[32:35], v[12:15], v[64:67]
    v_perm_b32 v51, v126, v122, s39
    v_mfma_f32_16x16x32_bf16 v[68:71], v[36:39], v[12:15], v[68:71]
    v_perm_b32 v55, v126, v122, s40
    v_mfma_f32_16x16x32_bf16 v[72:75], v[40:43], v[12:15], v[72:75]
    v_perm_b32 v59, v127, v123, s39
    v_mfma_f32_16x16x32_bf16 v[76:79], v[44:47], v[12:15], v[76:79]
    v_perm_b32 v63, v127, v123, s40
    s_waitcnt vmcnt(22)
    buffer_load_dwordx4 v[120:123], v1, s[20:23], s37 offen offset:2048 nt
    v_mfma_f32_16x16x32_bf16 v[80:83], v[48:51], v[12:15], v[80:83]
    v_perm_b32 v32, v132, v128, s39
    v_mfma_f32_16x16x32_bf16 v[84:87], v[52:55], v[12:15], v[84:87]
    v_perm_b32 v36, v132, v128, s40
    v_mfma_f32_16x16x32_bf16 v[88:91], v[56:59], v[12:15], v[88:91]
    v_perm_b32 v40, v133, v129, s39
    v_mfma_f32_16x16x32_bf16 v[92:95], v[60:63], v[12:15], v[92:95]
    v_perm_b32 v44, v133, v129, s40
    s_add_u32 s52, s52, 1
    v_mov_b32 v11, s52
    buffer_store_byte v11, off, s[60:63], s64
    buffer_load_ubyte v5, v0, s[60:63], 0 offen sc1
    s_waitcnt vmcnt(22)
    buffer_load_dwordx4 v[124:127], v1, s[20:23], s37 offen offset:3072 nt
    s_add_u32 s37, s37, 4096
    v_perm_b32 v48, v134, v130, s39
    v_perm_b32 v52, v134, v130, s40
    v_perm_b32 v56, v135, v131, s39
    v_perm_b32 v60, v135, v131, s40
    s_cbranch_vccz L_k0_1_np
    s_waitcnt vmcnt(22)
    buffer_load_dwordx4 v1, s[24:27], s46 offen lds
    s_add_u32 s46, s46, 8192
    s_add_u32 m0, m0, 9232
L_k0_1_np:
    s_waitcnt vmcnt(22)
    buffer_load_dwordx4 v[128:131], v1, s[20:23], s36 offen nt
    v_perm_b32 v33, v140, v136, s39
    v_perm_b32 v37, v140, v136, s40
    v_perm_b32 v41, v141, v137, s39
    v_perm_b32 v45, v141, v137, s40
    s_waitcnt vmcnt(22)
    buffer_load_dwordx4 v[132:135], v1, s[20:23], s36 offen offset:1024 nt
    v_perm_b32 v49, v142, v138, s39
    v_perm_b32 v53, v142, v138, s40
    v_perm_b32 v57, v143, v139, s39
    v_perm_b32 v61, v143, v139, s40
    s_waitcnt lgkmcnt(0)
    v_perm_b32 v12, v18, v16, s39
    v_perm_b32 v14, v19, v17, s39
    v_perm_b32 v13, v18, v16, s40
    v_perm_b32 v15, v19, v17, s40
    v_permlane32_swap_b32 v12, v14
    v_add_u32 v2, 32, v2
    v_permlane32_swap_b32 v13, v15
    ds_read_b128 v[16:19], v2
    s_waitcnt vmcnt(22)
    buffer_load_dwordx4 v[136:139], v1, s[20:23], s36 offen offset:2048 nt
    v_perm_b32 v34, v148, v144, s39
    v_perm_b32 v38, v148, v144, s40
    v_perm_b32 v42, v149, v145, s39
    v_perm_b32 v46, v149, v145, s40
    v_permlane16_swap_b32 v12, v13
    v_permlane16_swap_b32 v14, v15
    s_waitcnt vmcnt(22)
    buffer_load_dwordx4 v[140:143], v1, s[20:23], s36 offen offset:3072 nt
    s_add_u32 s36, s36, 4096
    v_perm_b32 v50, v150, v146, s39
    v_perm_b32 v54, v150, v146, s40
    v_perm_b32 v58, v151, v147, s39
    v_perm_b32 v62, v151, v147, s40
    s_waitcnt vmcnt(22)
    buffer_load_dwordx4 v[144:147], v1, s[20:23], s37 offen nt
    v_perm_b32 v35, v156, v152, s39
    v_perm_b32 v39, v156, v152, s40
    v_perm_b32 v43, v157, v153, s39
    v_perm_b32 v47, v157, v153, s40
    s_waitcnt vmcnt(22)
    buffer_load_dwordx4 v[148:151], v1, s[20:23], s37 offen offset:1024 nt
    v_mfma_f32_16x16x32_bf16 v[64:67], v[32:35], v[12:15], v[64:67]
    v_perm_b32 v51, v158, v154, s39
    v_mfma_f32_16x16x32_bf16 v[68:71], v[36:39], v[12:15], v[68:71]
    v_perm_b32 v55, v158, v154, s40
    v_mfma_f32_16x16x32_bf16 v[72:75], v[40:43], v[12:15], v[72:75]
    v_perm_b32 v59, v159, v155, s39
    v_mfma_f32_16x16x32_bf16 v[76:79], v[44:47], v[12:15], v[76:79]
    v_perm_b32 v63, v159, v155, s40
    s_waitcnt vmcnt(22)
    buffer_load_dwordx4 v[152:155], v1, s[20:23], s37 offen offset:2048 nt
    v_mfma_f32_16x16x32_bf16 v[80:83], v[48:51], v[12:15], v[80:83]
    v_perm_b32 v32, v164, v160, s39
    v_mfma_f32_16x16x32_bf16 v[84:87], v[52:55], v[12:15], v[84:87]
    v_perm_b32 v36, v164, v160, s40
    v_mfma_f32_16x16x32_bf16 v[88:91], v[56:59], v[12:15], v[88:91]
    v_perm_b32 v40, v165, v161, s39
    v_mfma_f32_16x16x32_bf16 v[92:95], v[60:63], v[12:15], v[92:95]
    v_perm_b32 v44, v165, v161, s40
    s_waitcnt vmcnt(22)
    buffer_load_dwordx4 v[156:159], v1, s[20:23], s37 offen offset:3072 nt
    s_add_u32 s37, s37, 4096
    v_perm_b32 v48, v166, v162, s39
    v_perm_b32 v52, v166, v162, s40
    v_perm_b32 v56, v167, v163, s39
    v_perm_b32 v60, v167, v163, s40
    s_cbranch_vccz L_k0_2_np
    s_waitcnt vmcnt(22)
    buffer_load_dwordx4 v1, s[24:27], s46 offen lds
    s_add_u32 s46, s46, 8192
    s_add_u32 m0, m0, 9232
L_k0_2_np:
    s_waitcnt vmcnt(22)
    buffer_load_dwordx4 v[160:163], v1, s[20:23], s36 offen nt
    v_perm_b32 v33, v172, v168, s39
    v_perm_b32 v37, v172, v168, s40
    v_perm_b32 v41, v173, v169, s39
    v_perm_b32 v45, v173, v169, s40
    s_waitcnt vmcnt(22)
    buffer_load_dwordx4 v[164:167], v1, s[20:23], s36 offen offset:1024 nt
    v_perm_b32 v49, v174, v170, s39
    v_perm_b32 v53, v174, v170, s40
    v_perm_b32 v57, v175, v171, s39
    v_perm_b32 v61, v175, v171, s40
    s_waitcnt lgkmcnt(0)
    v_perm_b32 v12, v18, v16, s39
    v_perm_b32 v14, v19, v17, s39
    v_perm_b32 v13, v18, v16, s40
    v_perm_b32 v15, v19, v17, s40
    v_permlane32_swap_b32 v12, v14
    v_add_u32 v2, 32, v2
    v_permlane32_swap_b32 v13, v15
    ds_read_b128 v[16:19], v2
    s_waitcnt vmcnt(22)
    buffer_load_dwordx4 v[168:171], v1, s[20:23], s36 offen offset:2048 nt
    v_perm_b32 v34, v180, v176, s39
    v_perm_b32 v38, v180, v176, s40
    v_perm_b32 v42, v181, v177, s39
    v_perm_b32 v46, v181, v177, s40
    v_permlane16_swap_b32 v12, v13
    v_permlane16_swap_b32 v14, v15
    s_waitcnt vmcnt(22)
    buffer_load_dwordx4 v[172:175], v1, s[20:23], s36 offen offset:3072 nt
    s_add_u32 s36, s36, 4096
    v_perm_b32 v50, v182, v178, s39
    v_perm_b32 v54, v182, v178, s40
    v_perm_b32 v58, v183, v179, s39
    v_perm_b32 v62, v183, v179, s40
    s_waitcnt vmcnt(22)
    buffer_load_dwordx4 v[176:179], v1, s[20:23], s37 offen nt
    v_perm_b32 v35, v188, v184, s39
    v_perm_b32 v39, v188, v184, s40
    v_perm_b32 v43, v189, v185, s39
    v_perm_b32 v47, v189, v185, s40
    s_waitcnt vmcnt(22)
    buffer_load_dwordx4 v[180:183], v1, s[20:23], s37 offen offset:1024 nt
    v_mfma_f32_16x16x32_bf16 v[64:67], v[32:35], v[12:15], v[64:67]
    v_perm_b32 v51, v190, v186, s39
    v_mfma_f32_16x16x32_bf16 v[68:71], v[36:39], v[12:15], v[68:71]
    v_perm_b32 v55, v190, v186, s40
    v_mfma_f32_16x16x32_bf16 v[72:75], v[40:43], v[12:15], v[72:75]
    v_perm_b32 v59, v191, v187, s39
    v_mfma_f32_16x16x32_bf16 v[76:79], v[44:47], v[12:15], v[76:79]
    v_perm_b32 v63, v191, v187, s40
    s_waitcnt vmcnt(22)
    buffer_load_dwordx4 v[184:187], v1, s[20:23], s37 offen offset:2048 nt
    v_mfma_f32_16x16x32_bf16 v[80:83], v[48:51], v[12:15], v[80:83]
    v_perm_b32 v32, v196, v192, s39
    v_mfma_f32_16x16x32_bf16 v[84:87], v[52:55], v[12:15], v[84:87]
    v_perm_b32 v36, v196, v192, s40
    v_mfma_f32_16x16x32_bf16 v[88:91], v[56:59], v[12:15], v[88:91]
    v_perm_b32 v40, v197, v193, s39
    v_mfma_f32_16x16x32_bf16 v[92:95], v[60:63], v[12:15], v[92:95]
    v_perm_b32 v44, v197, v193, s40
    s_waitcnt vmcnt(22)
    buffer_load_dwordx4 v[188:191], v1, s[20:23], s37 offen offset:3072 nt
    s_add_u32 s37, s37, 4096
    v_perm_b32 v48, v198, v194, s39
    v_perm_b32 v52, v198, v194, s40
    v_perm_b32 v56, v199, v195, s39
    v_perm_b32 v60, v199, v195, s40
    s_cbranch_vccz L_k0_3_np
    s_waitcnt vmcnt(22)
    buffer_load_dwordx4 v1, s[24:27], s46 offen lds
    s_add_u32 s46, s46, 8192
    s_add_u32 m0, m0, 9232
    s_cmp_ge_u32 s46, 0x20000
    s_cbranch_scc0 L_k0_3_np
    s_sub_u32 s46, s46, 130048
    s_sub_u32 m0, m0, 146688
    s_cmp_eq_u32 m0, 9216
    s_cselect_b32 m0, 0, m0
L_k0_3_np:
    s_waitcnt vmcnt(22)
    buffer_load_dwordx4 v[192:195], v1, s[20:23], s36 offen nt
    v_perm_b32 v33, v204, v200, s39
    v_perm_b32 v37, v204, v200, s40
    v_perm_b32 v41, v205, v201, s39
    v_perm_b32 v45, v205, v201, s40
    s_waitcnt vmcnt(22)
    buffer_load_dwordx4 v[196:199], v1, s[20:23], s36 offen offset:1024 nt
    v_perm_b32 v49, v206, v202, s39
    v_perm_b32 v53, v206, v202, s40
    v_perm_b32 v57, v207, v203, s39
    v_perm_b32 v61, v207, v203, s40
    s_waitcnt lgkmcnt(0)
    v_perm_b32 v12, v18, v16, s39
    v_perm_b32 v14, v19, v17, s39
    v_perm_b32 v13, v18, v16, s40
    v_perm_b32 v15, v19, v17, s40
    v_permlane32_swap_b32 v12, v14
    s_and_b32 s41, s38, 1
    s_cmp_eq_u32 s41, 1
    s_cselect_b32 s41, 288, 32
    v_add_u32 v2, s41, v2
    v_permlane32_swap_b32 v13, v15
    s_cmp_eq_u32 s38, 1
    s_cbranch_scc0 L_k0_3_nw
    v_add_u32 v2, s47, v4
L_k0_3_nw:
    ds_read_b128 v[16:19], v2
    s_waitcnt vmcnt(22)
    buffer_load_dwordx4 v[200:203], v1, s[20:23], s36 offen offset:2048 nt
    v_perm_b32 v34, v212, v208, s39
    v_perm_b32 v38, v212, v208, s40
    v_perm_b32 v42, v213, v209, s39
    v_perm_b32 v46, v213, v209, s40
    v_permlane16_swap_b32 v12, v13
    v_permlane16_swap_b32 v14, v15
    s_waitcnt vmcnt(22)
    buffer_load_dwordx4 v[204:207], v1, s[20:23], s36 offen offset:3072 nt
    s_add_u32 s36, s36, 4096
    s_and_b32 s41, s36, 32767
    s_cmp_eq_u32 s41, 0
    s_cselect_b32 s41, 32768, 0
    s_add_u32 s36, s36, s41
    v_perm_b32 v50, v214, v210, s39
    v_perm_b32 v54, v214, v210, s40
    v_perm_b32 v58, v215, v211, s39
    v_perm_b32 v62, v215, v211, s40
    s_waitcnt vmcnt(22)
    buffer_load_dwordx4 v[208:211], v1, s[20:23], s37 offen nt
    v_perm_b32 v35, v220, v216, s39
    v_perm_b32 v39, v220, v216, s40
    v_perm_b32 v43, v221, v217, s39
    v_perm_b32 v47, v221, v217, s40
    s_waitcnt vmcnt(22)
    buffer_load_dwordx4 v[212:215], v1, s[20:23], s37 offen offset:1024 nt
    v_mfma_f32_16x16x32_bf16 v[64:67], v[32:35], v[12:15], v[64:67]
    v_perm_b32 v51, v222, v218, s39
    v_mfma_f32_16x16x32_bf16 v[68:71], v[36:39], v[12:15], v[68:71]
    v_perm_b32 v55, v222, v218, s40
    v_mfma_f32_16x16x32_bf16 v[72:75], v[40:43], v[12:15], v[72:75]
    v_perm_b32 v59, v223, v219, s39
    v_mfma_f32_16x16x32_bf16 v[76:79], v[44:47], v[12:15], v[76:79]
    v_perm_b32 v63, v223, v219, s40
    s_branch L_k_next
L_km1:
    s_waitcnt vmcnt(26)
    buffer_load_dwordx4 v[216:219], v1, s[20:23], s37 offen offset:2048 nt
    v_mfma_f32_16x16x32_bf16 v[80:83], v[48:51], v[12:15], v[80:83]
    v_perm_b32 v32, v100, v96, s39
    v_mfma_f32_16x16x32_bf16 v[84:87], v[52:55], v[12:15], v[84:87]
    v_perm_b32 v36, v100, v96, s40
    v_mfma_f32_16x16x32_bf16 v[88:91], v[56:59], v[12:15], v[88:91]
    v_perm_b32 v40, v101, v97, s39
    v_mfma_f32_16x16x32_bf16 v[92:95], v[60:63], v[12:15], v[92:95]
    v_perm_b32 v44, v101, v97, s40
    s_waitcnt vmcnt(26)
    buffer_load_dwordx4 v[220:223], v1, s[20:23], s37 offen offset:3072 nt
    s_add_u32 s37, s37, 4096
    s_and_b32 s41, s37, 32767
    s_cmp_eq_u32 s41, 0
    s_cselect_b32 s41, 32768, 0
    s_add_u32 s37, s37, s41
    s_add_u32 s41, s38, s47
    s_cmp_eq_u32 s41, 8193
    s_cbranch_scc0 L_k1_0_ns
    s_mov_b32 s20, s8
    s_mov_b32 s21, s9
    s_lshl_b32 s36, s2, 21
    s_add_u32 s37, s36, 32768
L_k1_0_ns:
    v_perm_b32 v48, v102, v98, s39
    v_perm_b32 v52, v102, v98, s40
    v_perm_b32 v56, v103, v99, s39
    v_perm_b32 v60, v103, v99, s40
    s_cbranch_vccz L_k1_0_np
    s_waitcnt vmcnt(26)
    buffer_load_dwordx4 v1, s[24:27], s46 offen lds
    s_add_u32 s46, s46, 8192
    s_add_u32 m0, m0, 9232
L_k1_0_np:
    s_waitcnt vmcnt(26)
    buffer_load_dwordx4 v[96:99], v1, s[20:23], s36 offen nt
    v_perm_b32 v33, v108, v104, s39
    v_perm_b32 v37, v108, v104, s40
    v_perm_b32 v41, v109, v105, s39
    v_perm_b32 v45, v109, v105, s40
    s_waitcnt vmcnt(26)
    buffer_load_dwordx4 v[100:103], v1, s[20:23], s36 offen offset:1024 nt
    v_perm_b32 v49, v110, v106, s39
    v_perm_b32 v53, v110, v106, s40
    v_perm_b32 v57, v111, v107, s39
    v_perm_b32 v61, v111, v107, s40
    s_waitcnt lgkmcnt(0)
    v_perm_b32 v12, v18, v16, s39
    v_perm_b32 v14, v19, v17, s39
    v_perm_b32 v13, v18, v16, s40
    v_perm_b32 v15, v19, v17, s40
    v_permlane32_swap_b32 v12, v14
    v_add_u32 v2, 32, v2
    v_permlane32_swap_b32 v13, v15
    ds_read_b128 v[16:19], v2
    s_waitcnt vmcnt(26)
    buffer_load_dwordx4 v[104:107], v1, s[20:23], s36 offen offset:2048 nt
    v_perm_b32 v34, v116, v112, s39
    v_perm_b32 v38, v116, v112, s40
    v_perm_b32 v42, v117, v113, s39
    v_perm_b32 v46, v117, v113, s40
    v_permlane16_swap_b32 v12, v13
    v_permlane16_swap_b32 v14, v15
    s_waitcnt vmcnt(26)
    buffer_load_dwordx4 v[108:111], v1, s[20:23], s36 offen offset:3072 nt
    s_add_u32 s36, s36, 4096
    v_perm_b32 v50, v118, v114, s39
    v_perm_b32 v54, v118, v114, s40
    v_perm_b32 v58, v119, v115, s39
    v_perm_b32 v62, v119, v115, s40
    s_waitcnt vmcnt(26)
    buffer_load_dwordx4 v[112:115], v1, s[20:23], s37 offen nt
    v_perm_b32 v35, v124, v120, s39
    v_perm_b32 v39, v124, v120, s40
    v_perm_b32 v43, v125, v121, s39
    v_perm_b32 v47, v125, v121, s40
    s_waitcnt vmcnt(26)
    buffer_load_dwordx4 v[116:119], v1, s[20:23], s37 offen offset:1024 nt
    v_mfma_f32_16x16x32_bf16 v[64:67], v[32:35], v[12:15], v[64:67]
    v_perm_b32 v51, v126, v122, s39
    v_mfma_f32_16x16x32_bf16 v[68:71], v[36:39], v[12:15], v[68:71]
    v_perm_b32 v55, v126, v122, s40
    v_mfma_f32_16x16x32_bf16 v[72:75], v[40:43], v[12:15], v[72:75]
    v_perm_b32 v59, v127, v123, s39
    v_mfma_f32_16x16x32_bf16 v[76:79], v[44:47], v[12:15], v[76:79]
    v_perm_b32 v63, v127, v123, s40
    s_waitcnt vmcnt(26)
    buffer_load_dwordx4 v[120:123], v1, s[20:23], s37 offen offset:2048 nt
    v_mfma_f32_16x16x32_bf16 v[80:83], v[48:51], v[12:15], v[80:83]
    v_perm_b32 v32, v132, v128, s39
    v_mfma_f32_16x16x32_bf16 v[84:87], v[52:55], v[12:15], v[84:87]
    v_perm_b32 v36, v132, v128, s40
    v_mfma_f32_16x16x32_bf16 v[88:91], v[56:59], v[12:15], v[88:91]
    v_perm_b32 v40, v133, v129, s39
    v_mfma_f32_16x16x32_bf16 v[92:95], v[60:63], v[12:15], v[92:95]
    v_perm_b32 v44, v133, v129, s40
    s_add_u32 s52, s52, 1
    v_mov_b32 v11, s52
    buffer_store_byte v11, off, s[60:63], s64
    buffer_load_ubyte v5, v0, s[60:63], 0 offen sc1
    s_waitcnt vmcnt(26)
    buffer_load_dwordx4 v[124:127], v1, s[20:23], s37 offen offset:3072 nt
    s_add_u32 s37, s37, 4096
    v_perm_b32 v48, v134, v130, s39
    v_perm_b32 v52, v134, v130, s40
    v_perm_b32 v56, v135, v131, s39
    v_perm_b32 v60, v135, v131, s40
    s_cbranch_vccz L_k1_1_np
    s_waitcnt vmcnt(26)
    buffer_load_dwordx4 v1, s[24:27], s46 offen lds
    s_add_u32 s46, s46, 8192
    s_add_u32 m0, m0, 9232
L_k1_1_np:
    s_waitcnt vmcnt(26)
    buffer_load_dwordx4 v[128:131], v1, s[20:23], s36 offen nt
    v_perm_b32 v33, v140, v136, s39
    v_perm_b32 v37, v140, v136, s40
    v_perm_b32 v41, v141, v137, s39
    v_perm_b32 v45, v141, v137, s40
    s_waitcnt vmcnt(26)
    buffer_load_dwordx4 v[132:135], v1, s[20:23], s36 offen offset:1024 nt
    v_perm_b32 v49, v142, v138, s39
    v_perm_b32 v53, v142, v138, s40
    v_perm_b32 v57, v143, v139, s39
    v_perm_b32 v61, v143, v139, s40
    s_waitcnt lgkmcnt(0)
    v_perm_b32 v12, v18, v16, s39
    v_perm_b32 v14, v19, v17, s39
    v_perm_b32 v13, v18, v16, s40
    v_perm_b32 v15, v19, v17, s40
    v_permlane32_swap_b32 v12, v14
    v_add_u32 v2, 32, v2
    v_permlane32_swap_b32 v13, v15
    ds_read_b128 v[16:19], v2
    s_waitcnt vmcnt(26)
    buffer_load_dwordx4 v[136:139], v1, s[20:23], s36 offen offset:2048 nt
    v_perm_b32 v34, v148, v144, s39
    v_perm_b32 v38, v148, v144, s40
    v_perm_b32 v42, v149, v145, s39
    v_perm_b32 v46, v149, v145, s40
    v_permlane16_swap_b32 v12, v13
    v_permlane16_swap_b32 v14, v15
    s_waitcnt vmcnt(26)
    buffer_load_dwordx4 v[140:143], v1, s[20:23], s36 offen offset:3072 nt
    s_add_u32 s36, s36, 4096
    v_perm_b32 v50, v150, v146, s39
    v_perm_b32 v54, v150, v146, s40
    v_perm_b32 v58, v151, v147, s39
    v_perm_b32 v62, v151, v147, s40
    s_waitcnt vmcnt(26)
    buffer_load_dwordx4 v[144:147], v1, s[20:23], s37 offen nt
    v_perm_b32 v35, v156, v152, s39
    v_perm_b32 v39, v156, v152, s40
    v_perm_b32 v43, v157, v153, s39
    v_perm_b32 v47, v157, v153, s40
    s_waitcnt vmcnt(26)
    buffer_load_dwordx4 v[148:151], v1, s[20:23], s37 offen offset:1024 nt
    v_mfma_f32_16x16x32_bf16 v[64:67], v[32:35], v[12:15], v[64:67]
    v_perm_b32 v51, v158, v154, s39
    v_mfma_f32_16x16x32_bf16 v[68:71], v[36:39], v[12:15], v[68:71]
    v_perm_b32 v55, v158, v154, s40
    v_mfma_f32_16x16x32_bf16 v[72:75], v[40:43], v[12:15], v[72:75]
    v_perm_b32 v59, v159, v155, s39
    v_mfma_f32_16x16x32_bf16 v[76:79], v[44:47], v[12:15], v[76:79]
    v_perm_b32 v63, v159, v155, s40
    s_waitcnt vmcnt(26)
    buffer_load_dwordx4 v[152:155], v1, s[20:23], s37 offen offset:2048 nt
    v_mfma_f32_16x16x32_bf16 v[80:83], v[48:51], v[12:15], v[80:83]
    v_perm_b32 v32, v164, v160, s39
    v_mfma_f32_16x16x32_bf16 v[84:87], v[52:55], v[12:15], v[84:87]
    v_perm_b32 v36, v164, v160, s40
    v_mfma_f32_16x16x32_bf16 v[88:91], v[56:59], v[12:15], v[88:91]
    v_perm_b32 v40, v165, v161, s39
    v_mfma_f32_16x16x32_bf16 v[92:95], v[60:63], v[12:15], v[92:95]
    v_perm_b32 v44, v165, v161, s40
    s_waitcnt vmcnt(26)
    buffer_load_dwordx4 v[156:159], v1, s[20:23], s37 offen offset:3072 nt
    s_add_u32 s37, s37, 4096
    v_perm_b32 v48, v166, v162, s39
    v_perm_b32 v52, v166, v162, s40
    v_perm_b32 v56, v167, v163, s39
    v_perm_b32 v60, v167, v163, s40
    s_cbranch_vccz L_k1_2_np
    s_waitcnt vmcnt(26)
    buffer_load_dwordx4 v1, s[24:27], s46 offen lds
    s_add_u32 s46, s46, 8192
    s_add_u32 m0, m0, 9232
L_k1_2_np:
    s_waitcnt vmcnt(26)
    buffer_load_dwordx4 v[160:163], v1, s[20:23], s36 offen nt
    v_perm_b32 v33, v172, v168, s39
    v_perm_b32 v37, v172, v168, s40
    v_perm_b32 v41, v173, v169, s39
    v_perm_b32 v45, v173, v169, s40
    s_waitcnt vmcnt(26)
    buffer_load_dwordx4 v[164:167], v1, s[20:23], s36 offen offset:1024 nt
    v_perm_b32 v49, v174, v170, s39
    v_perm_b32 v53, v174, v170, s40
    v_perm_b32 v57, v175, v171, s39
    v_perm_b32 v61, v175, v171, s40
    s_waitcnt lgkmcnt(0)
    v_perm_b32 v12, v18, v16, s39
    v_perm_b32 v14, v19, v17, s39
    v_perm_b32 v13, v18, v16, s40
    v_perm_b32 v15, v19, v17, s40
    v_permlane32_swap_b32 v12, v14
    v_add_u32 v2, 32, v2
    v_permlane32_swap_b32 v13, v15
    ds_read_b128 v[16:19], v2
    s_waitcnt vmcnt(26)
    buffer_load_dwordx4 v[168:171], v1, s[20:23], s36 offen offset:2048 nt
    v_perm_b32 v34, v180, v176, s39
    v_perm_b32 v38, v180, v176, s40
    v_perm_b32 v42, v181, v177, s39
    v_perm_b32 v46, v181, v177, s40
    v_permlane16_swap_b32 v12, v13
    v_permlane16_swap_b32 v14, v15
    s_waitcnt vmcnt(26)
    buffer_load_dwordx4 v[172:175], v1, s[20:23], s36 offen offset:3072 nt
    s_add_u32 s36, s36, 4096
    v_perm_b32 v50, v182, v178, s39
    v_perm_b32 v54, v182, v178, s40
    v_perm_b32 v58, v183, v179, s39
    v_perm_b32 v62, v183, v179, s40
    s_waitcnt vmcnt(26)
    buffer_load_dwordx4 v[176:179], v1, s[20:23], s37 offen nt
    v_perm_b32 v35, v188, v184, s39
    v_perm_b32 v39, v188, v184, s40
    v_perm_b32 v43, v189, v185, s39
    v_perm_b32 v47, v189, v185, s40
    s_waitcnt vmcnt(26)
    buffer_load_dwordx4 v[180:183], v1, s[20:23], s37 offen offset:1024 nt
    v_mfma_f32_16x16x32_bf16 v[64:67], v[32:35], v[12:15], v[64:67]
    v_perm_b32 v51, v190, v186, s39
    v_mfma_f32_16x16x32_bf16 v[68:71], v[36:39], v[12:15], v[68:71]
    v_perm_b32 v55, v190, v186, s40
    v_mfma_f32_16x16x32_bf16 v[72:75], v[40:43], v[12:15], v[72:75]
    v_perm_b32 v59, v191, v187, s39
    v_mfma_f32_16x16x32_bf16 v[76:79], v[44:47], v[12:15], v[76:79]
    v_perm_b32 v63, v191, v187, s40
    s_waitcnt vmcnt(26)
    buffer_load_dwordx4 v[184:187], v1, s[20:23], s37 offen offset:2048 nt
    v_mfma_f32_16x16x32_bf16 v[80:83], v[48:51], v[12:15], v[80:83]
    v_perm_b32 v32, v196, v192, s39
    v_mfma_f32_16x16x32_bf16 v[84:87], v[52:55], v[12:15], v[84:87]
    v_perm_b32 v36, v196, v192, s40
    v_mfma_f32_16x16x32_bf16 v[88:91], v[56:59], v[12:15], v[88:91]
    v_perm_b32 v40, v197, v193, s39
    v_mfma_f32_16x16x32_bf16 v[92:95], v[60:63], v[12:15], v[92:95]
    v_perm_b32 v44, v197, v193, s40
    s_waitcnt vmcnt(26)
    buffer_load_dwordx4 v[188:191], v1, s[20:23], s37 offen offset:3072 nt
    s_add_u32 s37, s37, 4096
    v_perm_b32 v48, v198, v194, s39
    v_perm_b32 v52, v198, v194, s40
    v_perm_b32 v56, v199, v195, s39
    v_perm_b32 v60, v199, v195, s40
    s_cbranch_vccz L_k1_3_np
    s_waitcnt vmcnt(26)
    buffer_load_dwordx4 v1, s[24:27], s46 offen lds
    s_add_u32 s46, s46, 8192
    s_add_u32 m0, m0, 9232
    s_cmp_ge_u32 s46, 0x20000
    s_cbranch_scc0 L_k1_3_np
    s_sub_u32 s46, s46, 130048
    s_sub_u32 m0, m0, 146688
    s_cmp_eq_u32 m0, 9216
    s_cselect_b32 m0, 0, m0
L_k1_3_np:
    s_waitcnt vmcnt(26)
    buffer_load_dwordx4 v[192:195], v1, s[20:23], s36 offen nt
    v_perm_b32 v33, v204, v200, s39
    v_perm_b32 v37, v204, v200, s40
    v_perm_b32 v41, v205, v201, s39
    v_perm_b32 v45, v205, v201, s40
    s_waitcnt vmcnt(26)
    buffer_load_dwordx4 v[196:199], v1, s[20:23], s36 offen offset:1024 nt
    v_perm_b32 v49, v206, v202, s39
    v_perm_b32 v53, v206, v202, s40
    v_perm_b32 v57, v207, v203, s39
    v_perm_b32 v61, v207, v203, s40
    s_waitcnt lgkmcnt(0)
    v_perm_b32 v12, v18, v16, s39
    v_perm_b32 v14, v19, v17, s39
    v_perm_b32 v13, v18, v16, s40
    v_perm_b32 v15, v19, v17, s40
    v_permlane32_swap_b32 v12, v14
    s_and_b32 s41, s38, 1
    s_cmp_eq_u32 s41, 1
    s_cselect_b32 s41, 288, 32
    v_add_u32 v2, s41, v2
    v_permlane32_swap_b32 v13, v15
    s_cmp_eq_u32 s38, 1
    s_cbranch_scc0 L_k1_3_nw
    v_add_u32 v2, s47, v4
L_k1_3_nw:
    ds_read_b128 v[16:19], v2
    s_waitcnt vmcnt(26)
    buffer_load_dwordx4 v[200:203], v1, s[20:23], s36 offen offset:2048 nt
    v_perm_b32 v34, v212, v208, s39
    v_perm_b32 v38, v212, v208, s40
    v_perm_b32 v42, v213, v209, s39
    v_perm_b32 v46, v213, v209, s40
    v_permlane16_swap_b32 v12, v13
    v_permlane16_swap_b32 v14, v15
    s_waitcnt vmcnt(26)
    buffer_load_dwordx4 v[204:207], v1, s[20:23], s36 offen offset:3072 nt
    s_add_u32 s36, s36, 4096
    s_and_b32 s41, s36, 32767
    s_cmp_eq_u32 s41, 0
    s_cselect_b32 s41, 32768, 0
    s_add_u32 s36, s36, s41
    v_perm_b32 v50, v214, v210, s39
    v_perm_b32 v54, v214, v210, s40
    v_perm_b32 v58, v215, v211, s39
    v_perm_b32 v62, v215, v211, s40
    s_waitcnt vmcnt(26)
    buffer_load_dwordx4 v[208:211], v1, s[20:23], s37 offen nt
    v_perm_b32 v35, v220, v216, s39
    v_perm_b32 v39, v220, v216, s40
    v_perm_b32 v43, v221, v217, s39
    v_perm_b32 v47, v221, v217, s40
    s_waitcnt vmcnt(26)
    buffer_load_dwordx4 v[212:215], v1, s[20:23], s37 offen offset:1024 nt
    v_mfma_f32_16x16x32_bf16 v[64:67], v[32:35], v[12:15], v[64:67]
    v_perm_b32 v51, v222, v218, s39
    v_mfma_f32_16x16x32_bf16 v[68:71], v[36:39], v[12:15], v[68:71]
    v_perm_b32 v55, v222, v218, s40
    v_mfma_f32_16x16x32_bf16 v[72:75], v[40:43], v[12:15], v[72:75]
    v_perm_b32 v59, v223, v219, s39
    v_mfma_f32_16x16x32_bf16 v[76:79], v[44:47], v[12:15], v[76:79]
    v_perm_b32 v63, v223, v219, s40
L_k_next:
    s_sub_u32 s38, s38, 1
    s_cmp_lg_u32 s38, 0
    s_cbranch_scc1 L_k
    s_cmp_eq_u32 s47, 0
    s_mov_b32 s45, 0
    s_mov_b32 s47, 8192
    s_cbranch_scc0 L_vstart
    s_mov_b32 s38, 32
    s_mov_b64 vcc, -1
    s_waitcnt vmcnt(24)
    buffer_load_dwordx4 v[216:219], v1, s[20:23], s37 offen offset:2048 nt
    v_mfma_f32_16x16x32_bf16 v[80:83], v[48:51], v[12:15], v[80:83]
    v_perm_b32 v32, v100, v96, s39
    v_mfma_f32_16x16x32_bf16 v[84:87], v[52:55], v[12:15], v[84:87]
    v_perm_b32 v36, v100, v96, s40
    v_mfma_f32_16x16x32_bf16 v[88:91], v[56:59], v[12:15], v[88:91]
    v_perm_b32 v40, v101, v97, s39
    v_mfma_f32_16x16x32_bf16 v[92:95], v[60:63], v[12:15], v[92:95]
    v_perm_b32 v44, v101, v97, s40
    s_waitcnt vmcnt(24)
    buffer_load_dwordx4 v[220:223], v1, s[20:23], s37 offen offset:3072 nt
    s_add_u32 s37, s37, 4096
    s_and_b32 s41, s37, 32767
    s_cmp_eq_u32 s41, 0
    s_cselect_b32 s41, 32768, 0
    s_add_u32 s37, s37, s41
    v_perm_b32 v48, v102, v98, s39
    v_perm_b32 v52, v102, v98, s40
    v_perm_b32 v56, v103, v99, s39
    v_perm_b32 v60, v103, v99, s40
    ds_read_b128 v[224:227], v3 offset:0
    ds_read_b128 v[228:231], v3 offset:16
    ds_read_b128 v[232:235], v3 offset:32
    ds_read_b128 v[236:239], v3 offset:48
    v_cvt_pk_bf16_f32 v240, v64, v68
    v_cvt_pk_bf16_f32 v241, v72, v76
    v_cvt_pk_bf16_f32 v242, v80, v84
    v_cvt_pk_bf16_f32 v243, v88, v92
    s_cbranch_vccz L_kp_0_np
    s_waitcnt vmcnt(24)
    buffer_load_dwordx4 v1, s[24:27], s46 offen lds
    s_add_u32 s46, s46, 8192
    s_add_u32 m0, m0, 9232
L_kp_0_np:
    s_waitcnt vmcnt(24)
    buffer_load_dwordx4 v[96:99], v1, s[20:23], s36 offen nt
    v_perm_b32 v33, v108, v104, s39
    v_perm_b32 v37, v108, v104, s40
    v_perm_b32 v41, v109, v105, s39
    v_perm_b32 v45, v109, v105, s40
    v_cvt_pk_bf16_f32 v244, v65, v69
    v_cvt_pk_bf16_f32 v245, v73, v77
    v_cvt_pk_bf16_f32 v246, v81, v85
    v_cvt_pk_bf16_f32 v247, v89, v93
    v_cvt_pk_bf16_f32 v248, v66, v70
    v_cvt_pk_bf16_f32 v249, v74, v78
    v_cvt_pk_bf16_f32 v250, v82, v86
    v_cvt_pk_bf16_f32 v251, v90, v94
    v_add_u32 v3, 1024, v3
    s_waitcnt vmcnt(24)
    buffer_load_dwordx4 v[100:103], v1, s[20:23], s36 offen offset:1024 nt
    v_perm_b32 v49, v110, v106, s39
    v_perm_b32 v53, v110, v106, s40
    v_perm_b32 v57, v111, v107, s39
    v_perm_b32 v61, v111, v107, s40
    s_waitcnt lgkmcnt(0)
    v_perm_b32 v12, v18, v16, s39
    v_perm_b32 v14, v19, v17, s39
    v_perm_b32 v13, v18, v16, s40
    v_perm_b32 v15, v19, v17, s40
    v_permlane32_swap_b32 v12, v14
    v_add_u32 v2, 32, v2
    v_permlane32_swap_b32 v13, v15
    ds_read_b128 v[16:19], v2
    v_cvt_pk_bf16_f32 v252, v67, v71
    v_cvt_pk_bf16_f32 v253, v75, v79
    v_cvt_pk_bf16_f32 v254, v83, v87
    v_cvt_pk_bf16_f32 v255, v91, v95
    s_waitcnt vmcnt(24)
    buffer_load_dwordx4 v[104:107], v1, s[20:23], s36 offen offset:2048 nt
    v_perm_b32 v34, v116, v112, s39
    v_perm_b32 v38, v116, v112, s40
    v_perm_b32 v42, v117, v113, s39
    v_perm_b32 v46, v117, v113, s40
    v_permlane16_swap_b32 v12, v13
    v_permlane16_swap_b32 v14, v15
    v_mfma_f32_16x16x32_bf16 v[20:23], v[240:243], v[224:227], 0
    v_mfma_f32_16x16x32_bf16 v[20:23], v[244:247], v[228:231], v[20:23]
    s_waitcnt vmcnt(24)
    buffer_load_dwordx4 v[108:111], v1, s[20:23], s36 offen offset:3072 nt
    s_add_u32 s36, s36, 4096
    v_perm_b32 v50, v118, v114, s39
    v_perm_b32 v54, v118, v114, s40
    v_perm_b32 v58, v119, v115, s39
    v_perm_b32 v62, v119, v115, s40
    v_mfma_f32_16x16x32_bf16 v[20:23], v[248:251], v[232:235], v[20:23]
    v_mfma_f32_16x16x32_bf16 v[20:23], v[252:255], v[236:239], v[20:23]
    s_waitcnt vmcnt(24)
    buffer_load_dwordx4 v[112:115], v1, s[20:23], s37 offen nt
    v_perm_b32 v35, v124, v120, s39
    v_perm_b32 v39, v124, v120, s40
    v_perm_b32 v43, v125, v121, s39
    v_perm_b32 v47, v125, v121, s40
    s_waitcnt vmcnt(24)
    buffer_load_dwordx4 v[116:119], v1, s[20:23], s37 offen offset:1024 nt
    v_mfma_f32_16x16x32_bf16 v[64:67], v[32:35], v[12:15], 0
    v_perm_b32 v51, v126, v122, s39
    v_mfma_f32_16x16x32_bf16 v[68:71], v[36:39], v[12:15], 0
    v_perm_b32 v55, v126, v122, s40
    v_mfma_f32_16x16x32_bf16 v[72:75], v[40:43], v[12:15], 0
    v_perm_b32 v59, v127, v123, s39
    v_mfma_f32_16x16x32_bf16 v[76:79], v[44:47], v[12:15], 0
    v_perm_b32 v63, v127, v123, s40
    s_waitcnt vmcnt(24)
    buffer_load_dwordx4 v[120:123], v1, s[20:23], s37 offen offset:2048 nt
    v_mfma_f32_16x16x32_bf16 v[80:83], v[48:51], v[12:15], 0
    v_perm_b32 v32, v132, v128, s39
    v_mfma_f32_16x16x32_bf16 v[84:87], v[52:55], v[12:15], 0
    v_perm_b32 v36, v132, v128, s40
    v_mfma_f32_16x16x32_bf16 v[88:91], v[56:59], v[12:15], 0
    v_perm_b32 v40, v133, v129, s39
    v_mfma_f32_16x16x32_bf16 v[92:95], v[60:63], v[12:15], 0
    v_perm_b32 v44, v133, v129, s40
    s_add_u32 s52, s52, 1
    v_mov_b32 v11, s52
    buffer_store_byte v11, off, s[60:63], s64
    buffer_load_ubyte v5, v0, s[60:63], 0 offen sc1
    v_cvt_pk_bf16_f32 v28, v20, v21
    v_cvt_pk_bf16_f32 v29, v22, v23
    v_lshlrev_b32 v24, 16, v28
    v_and_b32 v25, 0xffff0000, v28
    s_waitcnt vmcnt(24)
    buffer_load_dwordx4 v[124:127], v1, s[20:23], s37 offen offset:3072 nt
    s_add_u32 s37, s37, 4096
    v_perm_b32 v48, v134, v130, s39
    v_perm_b32 v52, v134, v130, s40
    v_perm_b32 v56, v135, v131, s39
    v_perm_b32 v60, v135, v131, s40
    v_lshlrev_b32 v26, 16, v29
    v_and_b32 v27, 0xffff0000, v29
    v_mul_f32 v24, s43, v24
    v_mul_f32 v25, s43, v25
    s_cbranch_vccz L_kp_1_np
    s_waitcnt vmcnt(24)
    buffer_load_dwordx4 v1, s[24:27], s46 offen lds
    s_add_u32 s46, s46, 8192
    s_add_u32 m0, m0, 9232
L_kp_1_np:
    s_waitcnt vmcnt(24)
    buffer_load_dwordx4 v[128:131], v1, s[20:23], s36 offen nt
    v_perm_b32 v33, v140, v136, s39
    v_perm_b32 v37, v140, v136, s40
    v_perm_b32 v41, v141, v137, s39
    v_perm_b32 v45, v141, v137, s40
    v_mul_f32 v26, s43, v26
    v_mul_f32 v27, s43, v27
    v_cvt_pk_bf16_f32 v28, v24, v25
    v_cvt_pk_bf16_f32 v29, v26, v27
    s_waitcnt vmcnt(24)
    buffer_load_dwordx4 v[132:135], v1, s[20:23], s36 offen offset:1024 nt
    v_perm_b32 v49, v142, v138, s39
    v_perm_b32 v53, v142, v138, s40
    v_perm_b32 v57, v143, v139, s39
    v_perm_b32 v61, v143, v139, s40
    s_waitcnt lgkmcnt(0)
    v_perm_b32 v12, v18, v16, s39
    v_perm_b32 v14, v19, v17, s39
    v_perm_b32 v13, v18, v16, s40
    v_perm_b32 v15, v19, v17, s40
    v_permlane32_swap_b32 v12, v14
    v_add_u32 v2, 32, v2
    v_permlane32_swap_b32 v13, v15
    ds_read_b128 v[16:19], v2
    v_lshlrev_b32 v24, 16, v28
    v_and_b32 v25, 0xffff0000, v28
    v_lshlrev_b32 v26, 16, v29
    v_and_b32 v27, 0xffff0000, v29
    s_waitcnt vmcnt(24)
    buffer_load_dwordx4 v[136:139], v1, s[20:23], s36 offen offset:2048 nt
    v_perm_b32 v34, v148, v144, s39
    v_perm_b32 v38, v148, v144, s40
    v_perm_b32 v42, v149, v145, s39
    v_perm_b32 v46, v149, v145, s40
    v_permlane16_swap_b32 v12, v13
    v_permlane16_swap_b32 v14, v15
    v_max3_f32 v30, v24, v25, v26
    v_max_f32 v30, v30, v27
    v_mov_b32 v31, v30
    s_nop 1
    s_waitcnt vmcnt(24)
    buffer_load_dwordx4 v[140:143], v1, s[20:23], s36 offen offset:3072 nt
    s_add_u32 s36, s36, 4096
    v_perm_b32 v50, v150, v146, s39
    v_perm_b32 v54, v150, v146, s40
    v_perm_b32 v58, v151, v147, s39
    v_perm_b32 v62, v151, v147, s40
    v_permlane16_swap_b32 v30, v31
    s_nop 1
    v_max_f32 v30, v30, v31
    v_mov_b32 v31, v30
    s_waitcnt vmcnt(24)
    buffer_load_dwordx4 v[144:147], v1, s[20:23], s37 offen nt
    v_perm_b32 v35, v156, v152, s39
    v_perm_b32 v39, v156, v152, s40
    v_perm_b32 v43, v157, v153, s39
    v_perm_b32 v47, v157, v153, s40
    s_nop 1
    v_permlane32_swap_b32 v30, v31
    s_nop 1
    v_max_f32 v30, v30, v31
    s_waitcnt vmcnt(24)
    buffer_load_dwordx4 v[148:151], v1, s[20:23], s37 offen offset:1024 nt
    v_mfma_f32_16x16x32_bf16 v[64:67], v[32:35], v[12:15], v[64:67]
    v_perm_b32 v51, v158, v154, s39
    v_mfma_f32_16x16x32_bf16 v[68:71], v[36:39], v[12:15], v[68:71]
    v_perm_b32 v55, v158, v154, s40
    v_mfma_f32_16x16x32_bf16 v[72:75], v[40:43], v[12:15], v[72:75]
    v_perm_b32 v59, v159, v155, s39
    v_mfma_f32_16x16x32_bf16 v[76:79], v[44:47], v[12:15], v[76:79]
    v_perm_b32 v63, v159, v155, s40
    v_sub_f32 v24, v24, v30
    v_sub_f32 v25, v25, v30
    v_sub_f32 v26, v26, v30
    v_sub_f32 v27, v27, v30
    s_waitcnt vmcnt(24)
    buffer_load_dwordx4 v[152:155], v1, s[20:23], s37 offen offset:2048 nt
    v_mfma_f32_16x16x32_bf16 v[80:83], v[48:51], v[12:15], v[80:83]
    v_perm_b32 v32, v164, v160, s39
    v_mfma_f32_16x16x32_bf16 v[84:87], v[52:55], v[12:15], v[84:87]
    v_perm_b32 v36, v164, v160, s40
    v_mfma_f32_16x16x32_bf16 v[88:91], v[56:59], v[12:15], v[88:91]
    v_perm_b32 v40, v165, v161, s39
    v_mfma_f32_16x16x32_bf16 v[92:95], v[60:63], v[12:15], v[92:95]
    v_perm_b32 v44, v165, v161, s40
    v_mul_f32 v24, s44, v24
    v_mul_f32 v25, s44, v25
    v_mul_f32 v26, s44, v26
    v_mul_f32 v27, s44, v27
    s_waitcnt vmcnt(24)
    buffer_load_dwordx4 v[156:159], v1, s[20:23], s37 offen offset:3072 nt
    s_add_u32 s37, s37, 4096
    v_perm_b32 v48, v166, v162, s39
    v_perm_b32 v52, v166, v162, s40
    v_perm_b32 v56, v167, v163, s39
    v_perm_b32 v60, v167, v163, s40
    v_exp_f32 v24, v24
    v_exp_f32 v25, v25
    v_exp_f32 v26, v26
    v_exp_f32 v27, v27
    s_cbranch_vccz L_kp_2_np
    s_waitcnt vmcnt(24)
    buffer_load_dwordx4 v1, s[24:27], s46 offen lds
    s_add_u32 s46, s46, 8192
    s_add_u32 m0, m0, 9232
L_kp_2_np:
    s_waitcnt vmcnt(24)
    buffer_load_dwordx4 v[160:163], v1, s[20:23], s36 offen nt
    v_perm_b32 v33, v172, v168, s39
    v_perm_b32 v37, v172, v168, s40
    v_perm_b32 v41, v173, v169, s39
    v_perm_b32 v45, v173, v169, s40
    s_nop 0
    v_add_f32 v30, v24, v25
    v_add_f32 v31, v26, v27
    v_add_f32 v30, v30, v31
    s_waitcnt vmcnt(24)
    buffer_load_dwordx4 v[164:167], v1, s[20:23], s36 offen offset:1024 nt
    v_perm_b32 v49, v174, v170, s39
    v_perm_b32 v53, v174, v170, s40
    v_perm_b32 v57, v175, v171, s39
    v_perm_b32 v61, v175, v171, s40
    s_waitcnt lgkmcnt(0)
    v_perm_b32 v12, v18, v16, s39
    v_perm_b32 v14, v19, v17, s39
    v_perm_b32 v13, v18, v16, s40
    v_perm_b32 v15, v19, v17, s40
    v_permlane32_swap_b32 v12, v14
    v_add_u32 v2, 32, v2
    v_permlane32_swap_b32 v13, v15
    ds_read_b128 v[16:19], v2
    v_mov_b32 v31, v30
    s_nop 1
    v_permlane16_swap_b32 v30, v31
    s_nop 1
    s_waitcnt vmcnt(24)
    buffer_load_dwordx4 v[168:171], v1, s[20:23], s36 offen offset:2048 nt
    v_perm_b32 v34, v180, v176, s39
    v_perm_b32 v38, v180, v176, s40
    v_perm_b32 v42, v181, v177, s39
    v_perm_b32 v46, v181, v177, s40
    v_permlane16_swap_b32 v12, v13
    v_permlane16_swap_b32 v14, v15
    v_add_f32 v30, v30, v31
    v_mov_b32 v31, v30
    s_nop 1
    v_permlane32_swap_b32 v30, v31
    s_waitcnt vmcnt(24)
    buffer_load_dwordx4 v[172:175], v1, s[20:23], s36 offen offset:3072 nt
    s_add_u32 s36, s36, 4096
    v_perm_b32 v50, v182, v178, s39
    v_perm_b32 v54, v182, v178, s40
    v_perm_b32 v58, v183, v179, s39
    v_perm_b32 v62, v183, v179, s40
    s_nop 1
    v_add_f32 v30, v30, v31
    v_rcp_f32 v30, v30
    s_nop 0
    s_waitcnt vmcnt(24)
    buffer_load_dwordx4 v[176:179], v1, s[20:23], s37 offen nt
    v_perm_b32 v35, v188, v184, s39
    v_perm_b32 v39, v188, v184, s40
    v_perm_b32 v43, v189, v185, s39
    v_perm_b32 v47, v189, v185, s40
    v_mul_f32 v24, v24, v30
    v_mul_f32 v25, v25, v30
    v_mul_f32 v26, v26, v30
    v_mul_f32 v27, v27, v30
    s_waitcnt vmcnt(24)
    buffer_load_dwordx4 v[180:183], v1, s[20:23], s37 offen offset:1024 nt
    v_mfma_f32_16x16x32_bf16 v[64:67], v[32:35], v[12:15], v[64:67]
    v_perm_b32 v51, v190, v186, s39
    v_mfma_f32_16x16x32_bf16 v[68:71], v[36:39], v[12:15], v[68:71]
    v_perm_b32 v55, v190, v186, s40
    v_mfma_f32_16x16x32_bf16 v[72:75], v[40:43], v[12:15], v[72:75]
    v_perm_b32 v59, v191, v187, s39
    v_mfma_f32_16x16x32_bf16 v[76:79], v[44:47], v[12:15], v[76:79]
    v_perm_b32 v63, v191, v187, s40
    v_mov_b32 v6, v8
    v_mov_b32 v7, v9
    v_cvt_pk_bf16_f32 v8, v24, v25
    v_cvt_pk_bf16_f32 v9, v26, v27
    s_waitcnt vmcnt(24)
    buffer_load_dwordx4 v[184:187], v1, s[20:23], s37 offen offset:2048 nt
    v_mfma_f32_16x16x32_bf16 v[80:83], v[48:51], v[12:15], v[80:83]
    v_perm_b32 v32, v196, v192, s39
    v_mfma_f32_16x16x32_bf16 v[84:87], v[52:55], v[12:15], v[84:87]
    v_perm_b32 v36, v196, v192, s40
    v_mfma_f32_16x16x32_bf16 v[88:91], v[56:59], v[12:15], v[88:91]
    v_perm_b32 v40, v197, v193, s39
    v_mfma_f32_16x16x32_bf16 v[92:95], v[60:63], v[12:15], v[92:95]
    v_perm_b32 v44, v197, v193, s40
    s_waitcnt vmcnt(24)
    buffer_load_dwordx4 v[188:191], v1, s[20:23], s37 offen offset:3072 nt
    s_add_u32 s37, s37, 4096
    v_perm_b32 v48, v198, v194, s39
    v_perm_b32 v52, v198, v194, s40
    v_perm_b32 v56, v199, v195, s39
    v_perm_b32 v60, v199, v195, s40
    s_cbranch_vccz L_kp_3_np
    s_waitcnt vmcnt(24)
    buffer_load_dwordx4 v1, s[24:27], s46 offen lds
    s_add_u32 s46, s46, 8192
    s_add_u32 m0, m0, 9232
    s_cmp_ge_u32 s46, 0x20000
    s_cbranch_scc0 L_kp_3_np
    s_sub_u32 s46, s46, 130048
    s_sub_u32 m0, m0, 146688
    s_cmp_eq_u32 m0, 9216
    s_cselect_b32 m0, 0, m0
L_kp_3_np:
    s_waitcnt vmcnt(24)
    buffer_load_dwordx4 v[192:195], v1, s[20:23], s36 offen nt
    v_perm_b32 v33, v204, v200, s39
    v_perm_b32 v37, v204, v200, s40
    v_perm_b32 v41, v205, v201, s39
    v_perm_b32 v45, v205, v201, s40
    s_waitcnt vmcnt(24)
    buffer_load_dwordx4 v[196:199], v1, s[20:23], s36 offen offset:1024 nt
    v_perm_b32 v49, v206, v202, s39
    v_perm_b32 v53, v206, v202, s40
    v_perm_b32 v57, v207, v203, s39
    v_perm_b32 v61, v207, v203, s40
    s_waitcnt lgkmcnt(0)
    v_perm_b32 v12, v18, v16, s39
    v_perm_b32 v14, v19, v17, s39
    v_perm_b32 v13, v18, v16, s40
    v_perm_b32 v15, v19, v17, s40
    v_permlane32_swap_b32 v12, v14
    s_and_b32 s41, s38, 1
    s_cmp_eq_u32 s41, 1
    s_cselect_b32 s41, 288, 32
    v_add_u32 v2, s41, v2
    v_permlane32_swap_b32 v13, v15
    ds_read_b128 v[16:19], v2
    s_waitcnt vmcnt(24)
    buffer_load_dwordx4 v[200:203], v1, s[20:23], s36 offen offset:2048 nt
    v_perm_b32 v34, v212, v208, s39
    v_perm_b32 v38, v212, v208, s40
    v_perm_b32 v42, v213, v209, s39
    v_perm_b32 v46, v213, v209, s40
    v_permlane16_swap_b32 v12, v13
    v_permlane16_swap_b32 v14, v15
    s_waitcnt vmcnt(24)
    buffer_load_dwordx4 v[204:207], v1, s[20:23], s36 offen offset:3072 nt
    s_add_u32 s36, s36, 4096
    s_and_b32 s41, s36, 32767
    s_cmp_eq_u32 s41, 0
    s_cselect_b32 s41, 32768, 0
    s_add_u32 s36, s36, s41
    v_perm_b32 v50, v214, v210, s39
    v_perm_b32 v54, v214, v210, s40
    v_perm_b32 v58, v215, v211, s39
    v_perm_b32 v62, v215, v211, s40
    s_waitcnt vmcnt(24)
    buffer_load_dwordx4 v[208:211], v1, s[20:23], s37 offen nt
    v_perm_b32 v35, v220, v216, s39
    v_perm_b32 v39, v220, v216, s40
    v_perm_b32 v43, v221, v217, s39
    v_perm_b32 v47, v221, v217, s40
    s_waitcnt vmcnt(24)
    buffer_load_dwordx4 v[212:215], v1, s[20:23], s37 offen offset:1024 nt
    v_mfma_f32_16x16x32_bf16 v[64:67], v[32:35], v[12:15], v[64:67]
    v_perm_b32 v51, v222, v218, s39
    v_mfma_f32_16x16x32_bf16 v[68:71], v[36:39], v[12:15], v[68:71]
    v_perm_b32 v55, v222, v218, s40
    v_mfma_f32_16x16x32_bf16 v[72:75], v[40:43], v[12:15], v[72:75]
    v_perm_b32 v59, v223, v219, s39
    v_mfma_f32_16x16x32_bf16 v[76:79], v[44:47], v[12:15], v[76:79]
    v_perm_b32 v63, v223, v219, s40
    s_branch L_k_next
L_vstart:
    s_mov_b32 s38, 32
    s_waitcnt vmcnt(21)
    buffer_load_dwordx4 v[216:219], v1, s[20:23], s37 offen offset:2048 nt
    v_mfma_f32_16x16x32_bf16 v[80:83], v[48:51], v[12:15], v[80:83]
    v_perm_b32 v32, v100, v96, s39
    v_mfma_f32_16x16x32_bf16 v[84:87], v[52:55], v[12:15], v[84:87]
    v_perm_b32 v36, v100, v96, s40
    v_mfma_f32_16x16x32_bf16 v[88:91], v[56:59], v[12:15], v[88:91]
    v_perm_b32 v40, v101, v97, s39
    v_mfma_f32_16x16x32_bf16 v[92:95], v[60:63], v[12:15], v[92:95]
    v_perm_b32 v44, v101, v97, s40
    s_waitcnt vmcnt(21)
    buffer_load_dwordx4 v[220:223], v1, s[20:23], s37 offen offset:3072 nt
    s_add_u32 s37, s37, 4096
    s_and_b32 s41, s37, 32767
    s_cmp_eq_u32 s41, 0
    s_cselect_b32 s41, 32768, 0
    s_add_u32 s37, s37, s41
    v_perm_b32 v48, v102, v98, s39
    v_perm_b32 v52, v102, v98, s40
    v_perm_b32 v56, v103, v99, s39
    v_perm_b32 v60, v103, v99, s40
    ds_read_b128 v[224:227], v3 offset:0
    ds_read_b128 v[228:231], v3 offset:16
    ds_read_b128 v[232:235], v3 offset:32
    ds_read_b128 v[236:239], v3 offset:48
    v_cvt_pk_bf16_f32 v240, v64, v68
    v_cvt_pk_bf16_f32 v241, v72, v76
    v_cvt_pk_bf16_f32 v242, v80, v84
    v_cvt_pk_bf16_f32 v243, v88, v92
    s_waitcnt vmcnt(21)
    buffer_load_dwordx4 v[96:99], v1, s[20:23], s36 offen nt
    v_perm_b32 v33, v108, v104, s39
    v_perm_b32 v37, v108, v104, s40
    v_perm_b32 v41, v109, v105, s39
    v_perm_b32 v45, v109, v105, s40
    v_cvt_pk_bf16_f32 v244, v65, v69
    v_cvt_pk_bf16_f32 v245, v73, v77
    v_cvt_pk_bf16_f32 v246, v81, v85
    v_cvt_pk_bf16_f32 v247, v89, v93
    v_cvt_pk_bf16_f32 v248, v66, v70
    v_cvt_pk_bf16_f32 v249, v74, v78
    v_cvt_pk_bf16_f32 v250, v82, v86
    v_cvt_pk_bf16_f32 v251, v90, v94
    v_add_u32 v3, 1024, v3
    s_waitcnt vmcnt(21)
    buffer_load_dwordx4 v[100:103], v1, s[20:23], s36 offen offset:1024 nt
    v_perm_b32 v49, v110, v106, s39
    v_perm_b32 v53, v110, v106, s40
    v_perm_b32 v57, v111, v107, s39
    v_perm_b32 v61, v111, v107, s40
    s_waitcnt lgkmcnt(0)
    v_perm_b32 v12, v18, v16, s39
    v_perm_b32 v14, v19, v17, s39
    v_perm_b32 v13, v18, v16, s40
    v_perm_b32 v15, v19, v17, s40
    v_permlane32_swap_b32 v12, v14
    v_add_u32 v2, 32, v2
    v_permlane32_swap_b32 v13, v15
    ds_read_b128 v[16:19], v2
    v_cvt_pk_bf16_f32 v252, v67, v71
    v_cvt_pk_bf16_f32 v253, v75, v79
    v_cvt_pk_bf16_f32 v254, v83, v87
    v_cvt_pk_bf16_f32 v255, v91, v95
    s_waitcnt vmcnt(21)
    buffer_load_dwordx4 v[104:107], v1, s[20:23], s36 offen offset:2048 nt
    v_perm_b32 v34, v116, v112, s39
    v_perm_b32 v38, v116, v112, s40
    v_perm_b32 v42, v117, v113, s39
    v_perm_b32 v46, v117, v113, s40
    v_permlane16_swap_b32 v12, v13
    v_permlane16_swap_b32 v14, v15
    v_mfma_f32_16x16x32_bf16 v[20:23], v[240:243], v[224:227], 0
    v_mfma_f32_16x16x32_bf16 v[20:23], v[244:247], v[228:231], v[20:23]
    s_waitcnt vmcnt(21)
    buffer_load_dwordx4 v[108:111], v1, s[20:23], s36 offen offset:3072 nt
    s_add_u32 s36, s36, 4096
    v_perm_b32 v50, v118, v114, s39
    v_perm_b32 v54, v118, v114, s40
    v_perm_b32 v58, v119, v115, s39
    v_perm_b32 v62, v119, v115, s40
    v_mfma_f32_16x16x32_bf16 v[20:23], v[248:251], v[232:235], v[20:23]
    v_mfma_f32_16x16x32_bf16 v[20:23], v[252:255], v[236:239], v[20:23]
    s_waitcnt vmcnt(21)
    buffer_load_dwordx4 v[112:115], v1, s[20:23], s37 offen nt
    v_perm_b32 v35, v124, v120, s39
    v_perm_b32 v39, v124, v120, s40
    v_perm_b32 v43, v125, v121, s39
    v_perm_b32 v47, v125, v121, s40
    s_waitcnt vmcnt(21)
    buffer_load_dwordx4 v[116:119], v1, s[20:23], s37 offen offset:1024 nt
    v_mfma_f32_16x16x32_bf16 v[64:67], v[12:15], v[32:35], 0
    v_perm_b32 v51, v126, v122, s39
    v_mfma_f32_16x16x32_bf16 v[68:71], v[12:15], v[36:39], 0
    v_perm_b32 v55, v126, v122, s40
    v_mfma_f32_16x16x32_bf16 v[72:75], v[12:15], v[40:43], 0
    v_perm_b32 v59, v127, v123, s39
    v_mfma_f32_16x16x32_bf16 v[76:79], v[12:15], v[44:47], 0
    v_perm_b32 v63, v127, v123, s40
    s_waitcnt vmcnt(21)
    buffer_load_dwordx4 v[120:123], v1, s[20:23], s37 offen offset:2048 nt
    v_mfma_f32_16x16x32_bf16 v[80:83], v[12:15], v[48:51], 0
    v_perm_b32 v32, v132, v128, s39
    v_mfma_f32_16x16x32_bf16 v[84:87], v[12:15], v[52:55], 0
    v_perm_b32 v36, v132, v128, s40
    v_mfma_f32_16x16x32_bf16 v[88:91], v[12:15], v[56:59], 0
    v_perm_b32 v40, v133, v129, s39
    v_mfma_f32_16x16x32_bf16 v[92:95], v[12:15], v[60:63], 0
    v_perm_b32 v44, v133, v129, s40
    s_add_u32 s52, s52, 1
    v_mov_b32 v11, s52
    buffer_store_byte v11, off, s[60:63], s64
    buffer_load_ubyte v5, v0, s[60:63], 0 offen sc1
    v_cvt_pk_bf16_f32 v28, v20, v21
    v_cvt_pk_bf16_f32 v29, v22, v23
    v_lshlrev_b32 v24, 16, v28
    v_and_b32 v25, 0xffff0000, v28
    s_waitcnt vmcnt(21)
    buffer_load_dwordx4 v[124:127], v1, s[20:23], s37 offen offset:3072 nt
    s_add_u32 s37, s37, 4096
    v_perm_b32 v48, v134, v130, s39
    v_perm_b32 v52, v134, v130, s40
    v_perm_b32 v56, v135, v131, s39
    v_perm_b32 v60, v135, v131, s40
    v_lshlrev_b32 v26, 16, v29
    v_and_b32 v27, 0xffff0000, v29
    v_mul_f32 v24, s43, v24
    v_mul_f32 v25, s43, v25
    s_waitcnt vmcnt(21)
    buffer_load_dwordx4 v[128:131], v1, s[20:23], s36 offen nt
    v_perm_b32 v33, v140, v136, s39
    v_perm_b32 v37, v140, v136, s40
    v_perm_b32 v41, v141, v137, s39
    v_perm_b32 v45, v141, v137, s40
    v_mul_f32 v26, s43, v26
    v_mul_f32 v27, s43, v27
    v_cvt_pk_bf16_f32 v28, v24, v25
    v_cvt_pk_bf16_f32 v29, v26, v27
    s_waitcnt vmcnt(21)
    buffer_load_dwordx4 v[132:135], v1, s[20:23], s36 offen offset:1024 nt
    v_perm_b32 v49, v142, v138, s39
    v_perm_b32 v53, v142, v138, s40
    v_perm_b32 v57, v143, v139, s39
    v_perm_b32 v61, v143, v139, s40
    s_waitcnt lgkmcnt(0)
    v_perm_b32 v12, v18, v16, s39
    v_perm_b32 v14, v19, v17, s39
    v_perm_b32 v13, v18, v16, s40
    v_perm_b32 v15, v19, v17, s40
    v_permlane32_swap_b32 v12, v14
    v_add_u32 v2, 32, v2
    v_permlane32_swap_b32 v13, v15
    ds_read_b128 v[16:19], v2
    v_lshlrev_b32 v24, 16, v28
    v_and_b32 v25, 0xffff0000, v28
    v_lshlrev_b32 v26, 16, v29
    v_and_b32 v27, 0xffff0000, v29
    s_waitcnt vmcnt(21)
    buffer_load_dwordx4 v[136:139], v1, s[20:23], s36 offen offset:2048 nt
    v_perm_b32 v34, v148, v144, s39
    v_perm_b32 v38, v148, v144, s40
    v_perm_b32 v42, v149, v145, s39
    v_perm_b32 v46, v149, v145, s40
    v_permlane16_swap_b32 v12, v13
    v_permlane16_swap_b32 v14, v15
    v_max3_f32 v30, v24, v25, v26
    v_max_f32 v30, v30, v27
    v_mov_b32 v31, v30
    s_nop 1
    s_waitcnt vmcnt(21)
    buffer_load_dwordx4 v[140:143], v1, s[20:23], s36 offen offset:3072 nt
    s_add_u32 s36, s36, 4096
    v_perm_b32 v50, v150, v146, s39
    v_perm_b32 v54, v150, v146, s40
    v_perm_b32 v58, v151, v147, s39
    v_perm_b32 v62, v151, v147, s40
    v_permlane16_swap_b32 v30, v31
    s_nop 1
    v_max_f32 v30, v30, v31
    v_mov_b32 v31, v30
    s_waitcnt vmcnt(21)
    buffer_load_dwordx4 v[144:147], v1, s[20:23], s37 offen nt
    v_perm_b32 v35, v156, v152, s39
    v_perm_b32 v39, v156, v152, s40
    v_perm_b32 v43, v157, v153, s39
    v_perm_b32 v47, v157, v153, s40
    s_nop 1
    v_permlane32_swap_b32 v30, v31
    s_nop 1
    v_max_f32 v30, v30, v31
    s_waitcnt vmcnt(21)
    buffer_load_dwordx4 v[148:151], v1, s[20:23], s37 offen offset:1024 nt
    v_mfma_f32_16x16x32_bf16 v[64:67], v[12:15], v[32:35], v[64:67]
    v_perm_b32 v51, v158, v154, s39
    v_mfma_f32_16x16x32_bf16 v[68:71], v[12:15], v[36:39], v[68:71]
    v_perm_b32 v55, v158, v154, s40
    v_mfma_f32_16x16x32_bf16 v[72:75], v[12:15], v[40:43], v[72:75]
    v_perm_b32 v59, v159, v155, s39
    v_mfma_f32_16x16x32_bf16 v[76:79], v[12:15], v[44:47], v[76:79]
    v_perm_b32 v63, v159, v155, s40
    v_sub_f32 v24, v24, v30
    v_sub_f32 v25, v25, v30
    v_sub_f32 v26, v26, v30
    v_sub_f32 v27, v27, v30
    s_waitcnt vmcnt(21)
    buffer_load_dwordx4 v[152:155], v1, s[20:23], s37 offen offset:2048 nt
    v_mfma_f32_16x16x32_bf16 v[80:83], v[12:15], v[48:51], v[80:83]
    v_perm_b32 v32, v164, v160, s39
    v_mfma_f32_16x16x32_bf16 v[84:87], v[12:15], v[52:55], v[84:87]
    v_perm_b32 v36, v164, v160, s40
    v_mfma_f32_16x16x32_bf16 v[88:91], v[12:15], v[56:59], v[88:91]
    v_perm_b32 v40, v165, v161, s39
    v_mfma_f32_16x16x32_bf16 v[92:95], v[12:15], v[60:63], v[92:95]
    v_perm_b32 v44, v165, v161, s40
    v_mul_f32 v24, s44, v24
    v_mul_f32 v25, s44, v25
    v_mul_f32 v26, s44, v26
    v_mul_f32 v27, s44, v27
    s_waitcnt vmcnt(21)
    buffer_load_dwordx4 v[156:159], v1, s[20:23], s37 offen offset:3072 nt
    s_add_u32 s37, s37, 4096
    v_perm_b32 v48, v166, v162, s39
    v_perm_b32 v52, v166, v162, s40
    v_perm_b32 v56, v167, v163, s39
    v_perm_b32 v60, v167, v163, s40
    v_exp_f32 v24, v24
    v_exp_f32 v25, v25
    v_exp_f32 v26, v26
    v_exp_f32 v27, v27
    s_waitcnt vmcnt(21)
    buffer_load_dwordx4 v[160:163], v1, s[20:23], s36 offen nt
    v_perm_b32 v33, v172, v168, s39
    v_perm_b32 v37, v172, v168, s40
    v_perm_b32 v41, v173, v169, s39
    v_perm_b32 v45, v173, v169, s40
    s_nop 0
    v_add_f32 v30, v24, v25
    v_add_f32 v31, v26, v27
    v_add_f32 v30, v30, v31
    s_waitcnt vmcnt(21)
    buffer_load_dwordx4 v[164:167], v1, s[20:23], s36 offen offset:1024 nt
    v_perm_b32 v49, v174, v170, s39
    v_perm_b32 v53, v174, v170, s40
    v_perm_b32 v57, v175, v171, s39
    v_perm_b32 v61, v175, v171, s40
    s_waitcnt lgkmcnt(0)
    v_perm_b32 v12, v18, v16, s39
    v_perm_b32 v14, v19, v17, s39
    v_perm_b32 v13, v18, v16, s40
    v_perm_b32 v15, v19, v17, s40
    v_permlane32_swap_b32 v12, v14
    v_add_u32 v2, 32, v2
    v_permlane32_swap_b32 v13, v15
    ds_read_b128 v[16:19], v2
    v_mov_b32 v31, v30
    s_nop 1
    v_permlane16_swap_b32 v30, v31
    s_nop 1
    s_waitcnt vmcnt(21)
    buffer_load_dwordx4 v[168:171], v1, s[20:23], s36 offen offset:2048 nt
    v_perm_b32 v34, v180, v176, s39
    v_perm_b32 v38, v180, v176, s40
    v_perm_b32 v42, v181, v177, s39
    v_perm_b32 v46, v181, v177, s40
    v_permlane16_swap_b32 v12, v13
    v_permlane16_swap_b32 v14, v15
    v_add_f32 v30, v30, v31
    v_mov_b32 v31, v30
    s_nop 1
    v_permlane32_swap_b32 v30, v31
    s_waitcnt vmcnt(21)
    buffer_load_dwordx4 v[172:175], v1, s[20:23], s36 offen offset:3072 nt
    s_add_u32 s36, s36, 4096
    v_perm_b32 v50, v182, v178, s39
    v_perm_b32 v54, v182, v178, s40
    v_perm_b32 v58, v183, v179, s39
    v_perm_b32 v62, v183, v179, s40
    s_nop 1
    v_add_f32 v30, v30, v31
    v_rcp_f32 v30, v30
    s_nop 0
    s_waitcnt vmcnt(21)
    buffer_load_dwordx4 v[176:179], v1, s[20:23], s37 offen nt
    v_perm_b32 v35, v188, v184, s39
    v_perm_b32 v39, v188, v184, s40
    v_perm_b32 v43, v189, v185, s39
    v_perm_b32 v47, v189, v185, s40
    v_mul_f32 v24, v24, v30
    v_mul_f32 v25, v25, v30
    v_mul_f32 v26, v26, v30
    v_mul_f32 v27, v27, v30
    s_waitcnt vmcnt(21)
    buffer_load_dwordx4 v[180:183], v1, s[20:23], s37 offen offset:1024 nt
    v_mfma_f32_16x16x32_bf16 v[64:67], v[12:15], v[32:35], v[64:67]
    v_perm_b32 v51, v190, v186, s39
    v_mfma_f32_16x16x32_bf16 v[68:71], v[12:15], v[36:39], v[68:71]
    v_perm_b32 v55, v190, v186, s40
    v_mfma_f32_16x16x32_bf16 v[72:75], v[12:15], v[40:43], v[72:75]
    v_perm_b32 v59, v191, v187, s39
    v_mfma_f32_16x16x32_bf16 v[76:79], v[12:15], v[44:47], v[76:79]
    v_perm_b32 v63, v191, v187, s40
    v_mov_b32 v6, v8
    v_mov_b32 v7, v9
    v_cvt_pk_bf16_f32 v8, v24, v25
    v_cvt_pk_bf16_f32 v9, v26, v27
    s_waitcnt vmcnt(21)
    buffer_load_dwordx4 v[184:187], v1, s[20:23], s37 offen offset:2048 nt
    v_mfma_f32_16x16x32_bf16 v[80:83], v[12:15], v[48:51], v[80:83]
    v_perm_b32 v32, v196, v192, s39
    v_mfma_f32_16x16x32_bf16 v[84:87], v[12:15], v[52:55], v[84:87]
    v_perm_b32 v36, v196, v192, s40
    v_mfma_f32_16x16x32_bf16 v[88:91], v[12:15], v[56:59], v[88:91]
    v_perm_b32 v40, v197, v193, s39
    v_mfma_f32_16x16x32_bf16 v[92:95], v[12:15], v[60:63], v[92:95]
    v_perm_b32 v44, v197, v193, s40
    s_waitcnt vmcnt(21)
    buffer_load_dwordx4 v[188:191], v1, s[20:23], s37 offen offset:3072 nt
    s_add_u32 s37, s37, 4096
    v_perm_b32 v48, v198, v194, s39
    v_perm_b32 v52, v198, v194, s40
    v_perm_b32 v56, v199, v195, s39
    v_perm_b32 v60, v199, v195, s40
    s_waitcnt vmcnt(21)
    buffer_load_dwordx4 v[192:195], v1, s[20:23], s36 offen nt
    v_perm_b32 v33, v204, v200, s39
    v_perm_b32 v37, v204, v200, s40
    v_perm_b32 v41, v205, v201, s39
    v_perm_b32 v45, v205, v201, s40
    s_waitcnt vmcnt(21)
    buffer_load_dwordx4 v[196:199], v1, s[20:23], s36 offen offset:1024 nt
    v_perm_b32 v49, v206, v202, s39
    v_perm_b32 v53, v206, v202, s40
    v_perm_b32 v57, v207, v203, s39
    v_perm_b32 v61, v207, v203, s40
    s_waitcnt lgkmcnt(0)
    v_perm_b32 v12, v18, v16, s39
    v_perm_b32 v14, v19, v17, s39
    v_perm_b32 v13, v18, v16, s40
    v_perm_b32 v15, v19, v17, s40
    v_permlane32_swap_b32 v12, v14
    s_and_b32 s41, s38, 1
    s_cmp_eq_u32 s41, 1
    s_cselect_b32 s41, 288, 32
    v_add_u32 v2, s41, v2
    v_permlane32_swap_b32 v13, v15
    ds_read_b128 v[16:19], v2
    s_waitcnt vmcnt(21)
    buffer_load_dwordx4 v[200:203], v1, s[20:23], s36 offen offset:2048 nt
    v_perm_b32 v34, v212, v208, s39
    v_perm_b32 v38, v212, v208, s40
    v_perm_b32 v42, v213, v209, s39
    v_perm_b32 v46, v213, v209, s40
    v_permlane16_swap_b32 v12, v13
    v_permlane16_swap_b32 v14, v15
    s_waitcnt vmcnt(21)
    buffer_load_dwordx4 v[204:207], v1, s[20:23], s36 offen offset:3072 nt
    s_add_u32 s36, s36, 4096
    s_and_b32 s41, s36, 32767
    s_cmp_eq_u32 s41, 0
    s_cselect_b32 s41, 32768, 0
    s_add_u32 s36, s36, s41
    v_perm_b32 v50, v214, v210, s39
    v_perm_b32 v54, v214, v210, s40
    v_perm_b32 v58, v215, v211, s39
    v_perm_b32 v62, v215, v211, s40
    s_waitcnt vmcnt(21)
    buffer_load_dwordx4 v[208:211], v1, s[20:23], s37 offen nt
    v_perm_b32 v35, v220, v216, s39
    v_perm_b32 v39, v220, v216, s40
    v_perm_b32 v43, v221, v217, s39
    v_perm_b32 v47, v221, v217, s40
    s_waitcnt vmcnt(21)
    buffer_load_dwordx4 v[212:215], v1, s[20:23], s37 offen offset:1024 nt
    v_mfma_f32_16x16x32_bf16 v[64:67], v[12:15], v[32:35], v[64:67]
    v_perm_b32 v51, v222, v218, s39
    v_mfma_f32_16x16x32_bf16 v[68:71], v[12:15], v[36:39], v[68:71]
    v_perm_b32 v55, v222, v218, s40
    v_mfma_f32_16x16x32_bf16 v[72:75], v[12:15], v[40:43], v[72:75]
    v_perm_b32 v59, v223, v219, s39
    v_mfma_f32_16x16x32_bf16 v[76:79], v[12:15], v[44:47], v[76:79]
    v_perm_b32 v63, v223, v219, s40
    s_branch L_v_next
L_v:
    s_waitcnt vmcnt(23)
    v_cmp_le_u32 s[54:55], s52, v5
    s_nop 0
    s_bcnt1_i32_b64 s41, s[54:55]
    s_cmp_ge_u32 s41, s67
    s_cbranch_scc1 L_vm1
L_vm0:
    s_waitcnt vmcnt(19)
    buffer_load_dwordx4 v[216:219], v1, s[20:23], s37 offen offset:2048 nt
    v_mfma_f32_16x16x32_bf16 v[80:83], v[12:15], v[48:51], v[80:83]
    v_perm_b32 v32, v100, v96, s39
    v_mfma_f32_16x16x32_bf16 v[84:87], v[12:15], v[52:55], v[84:87]
    v_perm_b32 v36, v100, v96, s40
    v_mfma_f32_16x16x32_bf16 v[88:91], v[12:15], v[56:59], v[88:91]
    v_perm_b32 v40, v101, v97, s39
    v_mfma_f32_16x16x32_bf16 v[92:95], v[12:15], v[60:63], v[92:95]
    v_perm_b32 v44, v101, v97, s40
    s_waitcnt vmcnt(19)
    buffer_load_dwordx4 v[220:223], v1, s[20:23], s37 offen offset:3072 nt
    s_add_u32 s37, s37, 4096
    s_and_b32 s41, s37, 32767
    s_cmp_eq_u32 s41, 0
    s_cselect_b32 s41, 32768, 0
    s_add_u32 s37, s37, s41
    v_perm_b32 v48, v102, v98, s39
    v_perm_b32 v52, v102, v98, s40
    v_perm_b32 v56, v103, v99, s39
    v_perm_b32 v60, v103, v99, s40
    s_waitcnt vmcnt(19)
    buffer_load_dwordx4 v[96:99], v1, s[20:23], s36 offen nt
    v_perm_b32 v33, v108, v104, s39
    v_perm_b32 v37, v108, v104, s40
    v_perm_b32 v41, v109, v105, s39
    v_perm_b32 v45, v109, v105, s40
    s_waitcnt vmcnt(19)
    buffer_load_dwordx4 v[100:103], v1, s[20:23], s36 offen offset:1024 nt
    v_perm_b32 v49, v110, v106, s39
    v_perm_b32 v53, v110, v106, s40
    v_perm_b32 v57, v111, v107, s39
    v_perm_b32 v61, v111, v107, s40
    s_waitcnt lgkmcnt(0)
    v_perm_b32 v12, v18, v16, s39
    v_perm_b32 v14, v19, v17, s39
    v_perm_b32 v13, v18, v16, s40
    v_perm_b32 v15, v19, v17, s40
    v_permlane32_swap_b32 v12, v14
    v_add_u32 v2, 32, v2
    v_permlane32_swap_b32 v13, v15
    ds_read_b128 v[16:19], v2
    s_waitcnt vmcnt(19)
    buffer_load_dwordx4 v[104:107], v1, s[20:23], s36 offen offset:2048 nt
    v_perm_b32 v34, v116, v112, s39
    v_perm_b32 v38, v116, v112, s40
    v_perm_b32 v42, v117, v113, s39
    v_perm_b32 v46, v117, v113, s40
    v_permlane16_swap_b32 v12, v13
    v_permlane16_swap_b32 v14, v15
    s_waitcnt vmcnt(19)
    buffer_load_dwordx4 v[108:111], v1, s[20:23], s36 offen offset:3072 nt
    s_add_u32 s36, s36, 4096
    v_perm_b32 v50, v118, v114, s39
    v_perm_b32 v54, v118, v114, s40
    v_perm_b32 v58, v119, v115, s39
    v_perm_b32 v62, v119, v115, s40
    s_waitcnt vmcnt(19)
    buffer_load_dwordx4 v[112:115], v1, s[20:23], s37 offen nt
    v_perm_b32 v35, v124, v120, s39
    v_perm_b32 v39, v124, v120, s40
    v_perm_b32 v43, v125, v121, s39
    v_perm_b32 v47, v125, v121, s40
    s_waitcnt vmcnt(19)
    buffer_load_dwordx4 v[116:119], v1, s[20:23], s37 offen offset:1024 nt
    v_mfma_f32_16x16x32_bf16 v[64:67], v[12:15], v[32:35], v[64:67]
    v_perm_b32 v51, v126, v122, s39
    v_mfma_f32_16x16x32_bf16 v[68:71], v[12:15], v[36:39], v[68:71]
    v_perm_b32 v55, v126, v122, s40
    v_mfma_f32_16x16x32_bf16 v[72:75], v[12:15], v[40:43], v[72:75]
    v_perm_b32 v59, v127, v123, s39
    v_mfma_f32_16x16x32_bf16 v[76:79], v[12:15], v[44:47], v[76:79]
    v_perm_b32 v63, v127, v123, s40
    s_waitcnt vmcnt(19)
    buffer_load_dwordx4 v[120:123], v1, s[20:23], s37 offen offset:2048 nt
    v_mfma_f32_16x16x32_bf16 v[80:83], v[12:15], v[48:51], v[80:83]
    v_perm_b32 v32, v132, v128, s39
    v_mfma_f32_16x16x32_bf16 v[84:87], v[12:15], v[52:55], v[84:87]
    v_perm_b32 v36, v132, v128, s40
    v_mfma_f32_16x16x32_bf16 v[88:91], v[12:15], v[56:59], v[88:91]
    v_perm_b32 v40, v133, v129, s39
    v_mfma_f32_16x16x32_bf16 v[92:95], v[12:15], v[60:63], v[92:95]
    v_perm_b32 v44, v133, v129, s40
    s_add_u32 s52, s52, 1
    v_mov_b32 v11, s52
    buffer_store_byte v11, off, s[60:63], s64
    buffer_load_ubyte v5, v0, s[60:63], 0 offen sc1
    s_waitcnt vmcnt(19)
    buffer_load_dwordx4 v[124:127], v1, s[20:23], s37 offen offset:3072 nt
    s_add_u32 s37, s37, 4096
    v_perm_b32 v48, v134, v130, s39
    v_perm_b32 v52, v134, v130, s40
    v_perm_b32 v56, v135, v131, s39
    v_perm_b32 v60, v135, v131, s40
    s_waitcnt vmcnt(19)
    buffer_load_dwordx4 v[128:131], v1, s[20:23], s36 offen nt
    v_perm_b32 v33, v140, v136, s39
    v_perm_b32 v37, v140, v136, s40
    v_perm_b32 v41, v141, v137, s39
    v_perm_b32 v45, v141, v137, s40
    s_waitcnt vmcnt(19)
    buffer_load_dwordx4 v[132:135], v1, s[20:23], s36 offen offset:1024 nt
    v_perm_b32 v49, v142, v138, s39
    v_perm_b32 v53, v142, v138, s40
    v_perm_b32 v57, v143, v139, s39
    v_perm_b32 v61, v143, v139, s40
    s_waitcnt lgkmcnt(0)
    v_perm_b32 v12, v18, v16, s39
    v_perm_b32 v14, v19, v17, s39
    v_perm_b32 v13, v18, v16, s40
    v_perm_b32 v15, v19, v17, s40
    v_permlane32_swap_b32 v12, v14
    v_add_u32 v2, 32, v2
    v_permlane32_swap_b32 v13, v15
    ds_read_b128 v[16:19], v2
    s_waitcnt vmcnt(19)
    buffer_load_dwordx4 v[136:139], v1, s[20:23], s36 offen offset:2048 nt
    v_perm_b32 v34, v148, v144, s39
    v_perm_b32 v38, v148, v144, s40
    v_perm_b32 v42, v149, v145, s39
    v_perm_b32 v46, v149, v145, s40
    v_permlane16_swap_b32 v12, v13
    v_permlane16_swap_b32 v14, v15
    s_waitcnt vmcnt(19)
    buffer_load_dwordx4 v[140:143], v1, s[20:23], s36 offen offset:3072 nt
    s_add_u32 s36, s36, 4096
    v_perm_b32 v50, v150, v146, s39
    v_perm_b32 v54, v150, v146, s40
    v_perm_b32 v58, v151, v147, s39
    v_perm_b32 v62, v151, v147, s40
    s_waitcnt vmcnt(19)
    buffer_load_dwordx4 v[144:147], v1, s[20:23], s37 offen nt
    v_perm_b32 v35, v156, v152, s39
    v_perm_b32 v39, v156, v152, s40
    v_perm_b32 v43, v157, v153, s39
    v_perm_b32 v47, v157, v153, s40
    s_waitcnt vmcnt(19)
    buffer_load_dwordx4 v[148:151], v1, s[20:23], s37 offen offset:1024 nt
    v_mfma_f32_16x16x32_bf16 v[64:67], v[12:15], v[32:35], v[64:67]
    v_perm_b32 v51, v158, v154, s39
    v_mfma_f32_16x16x32_bf16 v[68:71], v[12:15], v[36:39], v[68:71]
    v_perm_b32 v55, v158, v154, s40
    v_mfma_f32_16x16x32_bf16 v[72:75], v[12:15], v[40:43], v[72:75]
    v_perm_b32 v59, v159, v155, s39
    v_mfma_f32_16x16x32_bf16 v[76:79], v[12:15], v[44:47], v[76:79]
    v_perm_b32 v63, v159, v155, s40
    s_waitcnt vmcnt(19)
    buffer_load_dwordx4 v[152:155], v1, s[20:23], s37 offen offset:2048 nt
    v_mfma_f32_16x16x32_bf16 v[80:83], v[12:15], v[48:51], v[80:83]
    v_perm_b32 v32, v164, v160, s39
    v_mfma_f32_16x16x32_bf16 v[84:87], v[12:15], v[52:55], v[84:87]
    v_perm_b32 v36, v164, v160, s40
    v_mfma_f32_16x16x32_bf16 v[88:91], v[12:15], v[56:59], v[88:91]
    v_perm_b32 v40, v165, v161, s39
    v_mfma_f32_16x16x32_bf16 v[92:95], v[12:15], v[60:63], v[92:95]
    v_perm_b32 v44, v165, v161, s40
    s_waitcnt vmcnt(19)
    buffer_load_dwordx4 v[156:159], v1, s[20:23], s37 offen offset:3072 nt
    s_add_u32 s37, s37, 4096
    v_perm_b32 v48, v166, v162, s39
    v_perm_b32 v52, v166, v162, s40
    v_perm_b32 v56, v167, v163, s39
    v_perm_b32 v60, v167, v163, s40
    s_waitcnt vmcnt(19)
    buffer_load_dwordx4 v[160:163], v1, s[20:23], s36 offen nt
    v_perm_b32 v33, v172, v168, s39
    v_perm_b32 v37, v172, v168, s40
    v_perm_b32 v41, v173, v169, s39
    v_perm_b32 v45, v173, v169, s40
    s_waitcnt vmcnt(19)
    buffer_load_dwordx4 v[164:167], v1, s[20:23], s36 offen offset:1024 nt
    v_perm_b32 v49, v174, v170, s39
    v_perm_b32 v53, v174, v170, s40
    v_perm_b32 v57, v175, v171, s39
    v_perm_b32 v61, v175, v171, s40
    s_waitcnt lgkmcnt(0)
    v_perm_b32 v12, v18, v16, s39
    v_perm_b32 v14, v19, v17, s39
    v_perm_b32 v13, v18, v16, s40
    v_perm_b32 v15, v19, v17, s40
    v_permlane32_swap_b32 v12, v14
    v_add_u32 v2, 32, v2
    v_permlane32_swap_b32 v13, v15
    ds_read_b128 v[16:19], v2
    s_waitcnt vmcnt(19)
    buffer_load_dwordx4 v[168:171], v1, s[20:23], s36 offen offset:2048 nt
    v_perm_b32 v34, v180, v176, s39
    v_perm_b32 v38, v180, v176, s40
    v_perm_b32 v42, v181, v177, s39
    v_perm_b32 v46, v181, v177, s40
    v_permlane16_swap_b32 v12, v13
    v_permlane16_swap_b32 v14, v15
    s_waitcnt vmcnt(19)
    buffer_load_dwordx4 v[172:175], v1, s[20:23], s36 offen offset:3072 nt
    s_add_u32 s36, s36, 4096
    v_perm_b32 v50, v182, v178, s39
    v_perm_b32 v54, v182, v178, s40
    v_perm_b32 v58, v183, v179, s39
    v_perm_b32 v62, v183, v179, s40
    s_waitcnt vmcnt(19)
    buffer_load_dwordx4 v[176:179], v1, s[20:23], s37 offen nt
    v_perm_b32 v35, v188, v184, s39
    v_perm_b32 v39, v188, v184, s40
    v_perm_b32 v43, v189, v185, s39
    v_perm_b32 v47, v189, v185, s40
    s_waitcnt vmcnt(19)
    buffer_load_dwordx4 v[180:183], v1, s[20:23], s37 offen offset:1024 nt
    v_mfma_f32_16x16x32_bf16 v[64:67], v[12:15], v[32:35], v[64:67]
    v_perm_b32 v51, v190, v186, s39
    v_mfma_f32_16x16x32_bf16 v[68:71], v[12:15], v[36:39], v[68:71]
    v_perm_b32 v55, v190, v186, s40
    v_mfma_f32_16x16x32_bf16 v[72:75], v[12:15], v[40:43], v[72:75]
    v_perm_b32 v59, v191, v187, s39
    v_mfma_f32_16x16x32_bf16 v[76:79], v[12:15], v[44:47], v[76:79]
    v_perm_b32 v63, v191, v187, s40
    s_waitcnt vmcnt(19)
    buffer_load_dwordx4 v[184:187], v1, s[20:23], s37 offen offset:2048 nt
    v_mfma_f32_16x16x32_bf16 v[80:83], v[12:15], v[48:51], v[80:83]
    v_perm_b32 v32, v196, v192, s39
    v_mfma_f32_16x16x32_bf16 v[84:87], v[12:15], v[52:55], v[84:87]
    v_perm_b32 v36, v196, v192, s40
    v_mfma_f32_16x16x32_bf16 v[88:91], v[12:15], v[56:59], v[88:91]
    v_perm_b32 v40, v197, v193, s39
    v_mfma_f32_16x16x32_bf16 v[92:95], v[12:15], v[60:63], v[92:95]
    v_perm_b32 v44, v197, v193, s40
    s_waitcnt vmcnt(19)
    buffer_load_dwordx4 v[188:191], v1, s[20:23], s37 offen offset:3072 nt
    s_add_u32 s37, s37, 4096
    v_perm_b32 v48, v198, v194, s39
    v_perm_b32 v52, v198, v194, s40
    v_perm_b32 v56, v199, v195, s39
    v_perm_b32 v60, v199, v195, s40
    s_waitcnt vmcnt(19)
    buffer_load_dwordx4 v[192:195], v1, s[20:23], s36 offen nt
    v_perm_b32 v33, v204, v200, s39
    v_perm_b32 v37, v204, v200, s40
    v_perm_b32 v41, v205, v201, s39
    v_perm_b32 v45, v205, v201, s40
    s_waitcnt vmcnt(19)
    buffer_load_dwordx4 v[196:199], v1, s[20:23], s36 offen offset:1024 nt
    v_perm_b32 v49, v206, v202, s39
    v_perm_b32 v53, v206, v202, s40
    v_perm_b32 v57, v207, v203, s39
    v_perm_b32 v61, v207, v203, s40
    s_waitcnt lgkmcnt(0)
    v_perm_b32 v12, v18, v16, s39
    v_perm_b32 v14, v19, v17, s39
    v_perm_b32 v13, v18, v16, s40
    v_perm_b32 v15, v19, v17, s40
    v_permlane32_swap_b32 v12, v14
    s_and_b32 s41, s38, 1
    s_cmp_eq_u32 s41, 1
    s_cselect_b32 s41, 288, 32
    v_add_u32 v2, s41, v2
    v_permlane32_swap_b32 v13, v15
    s_cmp_eq_u32 s38, 29
    s_cbranch_scc0 L_v0_3_nw
    v_mov_b32 v2, v4
L_v0_3_nw:
    s_cmp_eq_u32 s38, 1
    s_cbranch_scc0 L_v0_3_nx
    v_add_u32 v2, 8192, v4
L_v0_3_nx:
    ds_read_b128 v[16:19], v2
    s_waitcnt vmcnt(19)
    buffer_load_dwordx4 v[200:203], v1, s[20:23], s36 offen offset:2048 nt
    v_perm_b32 v34, v212, v208, s39
    v_perm_b32 v38, v212, v208, s40
    v_perm_b32 v42, v213, v209, s39
    v_perm_b32 v46, v213, v209, s40
    v_permlane16_swap_b32 v12, v13
    v_permlane16_swap_b32 v14, v15
    s_waitcnt vmcnt(19)
    buffer_load_dwordx4 v[204:207], v1, s[20:23], s36 offen offset:3072 nt
    s_add_u32 s36, s36, 4096
    s_and_b32 s41, s36, 32767
    s_cmp_eq_u32 s41, 0
    s_cselect_b32 s41, 32768, 0
    s_add_u32 s36, s36, s41
    v_perm_b32 v50, v214, v210, s39
    v_perm_b32 v54, v214, v210, s40
    v_perm_b32 v58, v215, v211, s39
    v_perm_b32 v62, v215, v211, s40
    s_waitcnt vmcnt(19)
    buffer_load_dwordx4 v[208:211], v1, s[20:23], s37 offen nt
    v_perm_b32 v35, v220, v216, s39
    v_perm_b32 v39, v220, v216, s40
    v_perm_b32 v43, v221, v217, s39
    v_perm_b32 v47, v221, v217, s40
    s_waitcnt vmcnt(19)
    buffer_load_dwordx4 v[212:215], v1, s[20:23], s37 offen offset:1024 nt
    v_mfma_f32_16x16x32_bf16 v[64:67], v[12:15], v[32:35], v[64:67]
    v_perm_b32 v51, v222, v218, s39
    v_mfma_f32_16x16x32_bf16 v[68:71], v[12:15], v[36:39], v[68:71]
    v_perm_b32 v55, v222, v218, s40
    v_mfma_f32_16x16x32_bf16 v[72:75], v[12:15], v[40:43], v[72:75]
    v_perm_b32 v59, v223, v219, s39
    v_mfma_f32_16x16x32_bf16 v[76:79], v[12:15], v[44:47], v[76:79]
    v_perm_b32 v63, v223, v219, s40
    s_branch L_v_next
L_vm1:
    s_waitcnt vmcnt(23)
    buffer_load_dwordx4 v[216:219], v1, s[20:23], s37 offen offset:2048 nt
    v_mfma_f32_16x16x32_bf16 v[80:83], v[12:15], v[48:51], v[80:83]
    v_perm_b32 v32, v100, v96, s39
    v_mfma_f32_16x16x32_bf16 v[84:87], v[12:15], v[52:55], v[84:87]
    v_perm_b32 v36, v100, v96, s40
    v_mfma_f32_16x16x32_bf16 v[88:91], v[12:15], v[56:59], v[88:91]
    v_perm_b32 v40, v101, v97, s39
    v_mfma_f32_16x16x32_bf16 v[92:95], v[12:15], v[60:63], v[92:95]
    v_perm_b32 v44, v101, v97, s40
    s_waitcnt vmcnt(23)
    buffer_load_dwordx4 v[220:223], v1, s[20:23], s37 offen offset:3072 nt
    s_add_u32 s37, s37, 4096
    s_and_b32 s41, s37, 32767
    s_cmp_eq_u32 s41, 0
    s_cselect_b32 s41, 32768, 0
    s_add_u32 s37, s37, s41
    v_perm_b32 v48, v102, v98, s39
    v_perm_b32 v52, v102, v98, s40
    v_perm_b32 v56, v103, v99, s39
    v_perm_b32 v60, v103, v99, s40
    s_waitcnt vmcnt(23)
    buffer_load_dwordx4 v[96:99], v1, s[20:23], s36 offen nt
    v_perm_b32 v33, v108, v104, s39
    v_perm_b32 v37, v108, v104, s40
    v_perm_b32 v41, v109, v105, s39
    v_perm_b32 v45, v109, v105, s40
    s_waitcnt vmcnt(23)
    buffer_load_dwordx4 v[100:103], v1, s[20:23], s36 offen offset:1024 nt
    v_perm_b32 v49, v110, v106, s39
    v_perm_b32 v53, v110, v106, s40
    v_perm_b32 v57, v111, v107, s39
    v_perm_b32 v61, v111, v107, s40
    s_waitcnt lgkmcnt(0)
    v_perm_b32 v12, v18, v16, s39
    v_perm_b32 v14, v19, v17, s39
    v_perm_b32 v13, v18, v16, s40
    v_perm_b32 v15, v19, v17, s40
    v_permlane32_swap_b32 v12, v14
    v_add_u32 v2, 32, v2
    v_permlane32_swap_b32 v13, v15
    ds_read_b128 v[16:19], v2
    s_waitcnt vmcnt(23)
    buffer_load_dwordx4 v[104:107], v1, s[20:23], s36 offen offset:2048 nt
    v_perm_b32 v34, v116, v112, s39
    v_perm_b32 v38, v116, v112, s40
    v_perm_b32 v42, v117, v113, s39
    v_perm_b32 v46, v117, v113, s40
    v_permlane16_swap_b32 v12, v13
    v_permlane16_swap_b32 v14, v15
    s_waitcnt vmcnt(23)
    buffer_load_dwordx4 v[108:111], v1, s[20:23], s36 offen offset:3072 nt
    s_add_u32 s36, s36, 4096
    v_perm_b32 v50, v118, v114, s39
    v_perm_b32 v54, v118, v114, s40
    v_perm_b32 v58, v119, v115, s39
    v_perm_b32 v62, v119, v115, s40
    s_waitcnt vmcnt(23)
    buffer_load_dwordx4 v[112:115], v1, s[20:23], s37 offen nt
    v_perm_b32 v35, v124, v120, s39
    v_perm_b32 v39, v124, v120, s40
    v_perm_b32 v43, v125, v121, s39
    v_perm_b32 v47, v125, v121, s40
    s_waitcnt vmcnt(23)
    buffer_load_dwordx4 v[116:119], v1, s[20:23], s37 offen offset:1024 nt
    v_mfma_f32_16x16x32_bf16 v[64:67], v[12:15], v[32:35], v[64:67]
    v_perm_b32 v51, v126, v122, s39
    v_mfma_f32_16x16x32_bf16 v[68:71], v[12:15], v[36:39], v[68:71]
    v_perm_b32 v55, v126, v122, s40
    v_mfma_f32_16x16x32_bf16 v[72:75], v[12:15], v[40:43], v[72:75]
    v_perm_b32 v59, v127, v123, s39
    v_mfma_f32_16x16x32_bf16 v[76:79], v[12:15], v[44:47], v[76:79]
    v_perm_b32 v63, v127, v123, s40
    s_waitcnt vmcnt(23)
    buffer_load_dwordx4 v[120:123], v1, s[20:23], s37 offen offset:2048 nt
    v_mfma_f32_16x16x32_bf16 v[80:83], v[12:15], v[48:51], v[80:83]
    v_perm_b32 v32, v132, v128, s39
    v_mfma_f32_16x16x32_bf16 v[84:87], v[12:15], v[52:55], v[84:87]
    v_perm_b32 v36, v132, v128, s40
    v_mfma_f32_16x16x32_bf16 v[88:91], v[12:15], v[56:59], v[88:91]
    v_perm_b32 v40, v133, v129, s39
    v_mfma_f32_16x16x32_bf16 v[92:95], v[12:15], v[60:63], v[92:95]
    v_perm_b32 v44, v133, v129, s40
    s_add_u32 s52, s52, 1
    v_mov_b32 v11, s52
    buffer_store_byte v11, off, s[60:63], s64
    buffer_load_ubyte v5, v0, s[60:63], 0 offen sc1
    s_waitcnt vmcnt(23)
    buffer_load_dwordx4 v[124:127], v1, s[20:23], s37 offen offset:3072 nt
    s_add_u32 s37, s37, 4096
    v_perm_b32 v48, v134, v130, s39
    v_perm_b32 v52, v134, v130, s40
    v_perm_b32 v56, v135, v131, s39
    v_perm_b32 v60, v135, v131, s40
    s_waitcnt vmcnt(23)
    buffer_load_dwordx4 v[128:131], v1, s[20:23], s36 offen nt
    v_perm_b32 v33, v140, v136, s39
    v_perm_b32 v37, v140, v136, s40
    v_perm_b32 v41, v141, v137, s39
    v_perm_b32 v45, v141, v137, s40
    s_waitcnt vmcnt(23)
    buffer_load_dwordx4 v[132:135], v1, s[20:23], s36 offen offset:1024 nt
    v_perm_b32 v49, v142, v138, s39
    v_perm_b32 v53, v142, v138, s40
    v_perm_b32 v57, v143, v139, s39
    v_perm_b32 v61, v143, v139, s40
    s_waitcnt lgkmcnt(0)
    v_perm_b32 v12, v18, v16, s39
    v_perm_b32 v14, v19, v17, s39
    v_perm_b32 v13, v18, v16, s40
    v_perm_b32 v15, v19, v17, s40
    v_permlane32_swap_b32 v12, v14
    v_add_u32 v2, 32, v2
    v_permlane32_swap_b32 v13, v15
    ds_read_b128 v[16:19], v2
    s_waitcnt vmcnt(23)
    buffer_load_dwordx4 v[136:139], v1, s[20:23], s36 offen offset:2048 nt
    v_perm_b32 v34, v148, v144, s39
    v_perm_b32 v38, v148, v144, s40
    v_perm_b32 v42, v149, v145, s39
    v_perm_b32 v46, v149, v145, s40
    v_permlane16_swap_b32 v12, v13
    v_permlane16_swap_b32 v14, v15
    s_waitcnt vmcnt(23)
    buffer_load_dwordx4 v[140:143], v1, s[20:23], s36 offen offset:3072 nt
    s_add_u32 s36, s36, 4096
    v_perm_b32 v50, v150, v146, s39
    v_perm_b32 v54, v150, v146, s40
    v_perm_b32 v58, v151, v147, s39
    v_perm_b32 v62, v151, v147, s40
    s_waitcnt vmcnt(23)
    buffer_load_dwordx4 v[144:147], v1, s[20:23], s37 offen nt
    v_perm_b32 v35, v156, v152, s39
    v_perm_b32 v39, v156, v152, s40
    v_perm_b32 v43, v157, v153, s39
    v_perm_b32 v47, v157, v153, s40
    s_waitcnt vmcnt(23)
    buffer_load_dwordx4 v[148:151], v1, s[20:23], s37 offen offset:1024 nt
    v_mfma_f32_16x16x32_bf16 v[64:67], v[12:15], v[32:35], v[64:67]
    v_perm_b32 v51, v158, v154, s39
    v_mfma_f32_16x16x32_bf16 v[68:71], v[12:15], v[36:39], v[68:71]
    v_perm_b32 v55, v158, v154, s40
    v_mfma_f32_16x16x32_bf16 v[72:75], v[12:15], v[40:43], v[72:75]
    v_perm_b32 v59, v159, v155, s39
    v_mfma_f32_16x16x32_bf16 v[76:79], v[12:15], v[44:47], v[76:79]
    v_perm_b32 v63, v159, v155, s40
    s_waitcnt vmcnt(23)
    buffer_load_dwordx4 v[152:155], v1, s[20:23], s37 offen offset:2048 nt
    v_mfma_f32_16x16x32_bf16 v[80:83], v[12:15], v[48:51], v[80:83]
    v_perm_b32 v32, v164, v160, s39
    v_mfma_f32_16x16x32_bf16 v[84:87], v[12:15], v[52:55], v[84:87]
    v_perm_b32 v36, v164, v160, s40
    v_mfma_f32_16x16x32_bf16 v[88:91], v[12:15], v[56:59], v[88:91]
    v_perm_b32 v40, v165, v161, s39
    v_mfma_f32_16x16x32_bf16 v[92:95], v[12:15], v[60:63], v[92:95]
    v_perm_b32 v44, v165, v161, s40
    s_waitcnt vmcnt(23)
    buffer_load_dwordx4 v[156:159], v1, s[20:23], s37 offen offset:3072 nt
    s_add_u32 s37, s37, 4096
    v_perm_b32 v48, v166, v162, s39
    v_perm_b32 v52, v166, v162, s40
    v_perm_b32 v56, v167, v163, s39
    v_perm_b32 v60, v167, v163, s40
    s_waitcnt vmcnt(23)
    buffer_load_dwordx4 v[160:163], v1, s[20:23], s36 offen nt
    v_perm_b32 v33, v172, v168, s39
    v_perm_b32 v37, v172, v168, s40
    v_perm_b32 v41, v173, v169, s39
    v_perm_b32 v45, v173, v169, s40
    s_waitcnt vmcnt(23)
    buffer_load_dwordx4 v[164:167], v1, s[20:23], s36 offen offset:1024 nt
    v_perm_b32 v49, v174, v170, s39
    v_perm_b32 v53, v174, v170, s40
    v_perm_b32 v57, v175, v171, s39
    v_perm_b32 v61, v175, v171, s40
    s_waitcnt lgkmcnt(0)
    v_perm_b32 v12, v18, v16, s39
    v_perm_b32 v14, v19, v17, s39
    v_perm_b32 v13, v18, v16, s40
    v_perm_b32 v15, v19, v17, s40
    v_permlane32_swap_b32 v12, v14
    v_add_u32 v2, 32, v2
    v_permlane32_swap_b32 v13, v15
    ds_read_b128 v[16:19], v2
    s_waitcnt vmcnt(23)
    buffer_load_dwordx4 v[168:171], v1, s[20:23], s36 offen offset:2048 nt
    v_perm_b32 v34, v180, v176, s39
    v_perm_b32 v38, v180, v176, s40
    v_perm_b32 v42, v181, v177, s39
    v_perm_b32 v46, v181, v177, s40
    v_permlane16_swap_b32 v12, v13
    v_permlane16_swap_b32 v14, v15
    s_waitcnt vmcnt(23)
    buffer_load_dwordx4 v[172:175], v1, s[20:23], s36 offen offset:3072 nt
    s_add_u32 s36, s36, 4096
    v_perm_b32 v50, v182, v178, s39
    v_perm_b32 v54, v182, v178, s40
    v_perm_b32 v58, v183, v179, s39
    v_perm_b32 v62, v183, v179, s40
    s_waitcnt vmcnt(23)
    buffer_load_dwordx4 v[176:179], v1, s[20:23], s37 offen nt
    v_perm_b32 v35, v188, v184, s39
    v_perm_b32 v39, v188, v184, s40
    v_perm_b32 v43, v189, v185, s39
    v_perm_b32 v47, v189, v185, s40
    s_waitcnt vmcnt(23)
    buffer_load_dwordx4 v[180:183], v1, s[20:23], s37 offen offset:1024 nt
    v_mfma_f32_16x16x32_bf16 v[64:67], v[12:15], v[32:35], v[64:67]
    v_perm_b32 v51, v190, v186, s39
    v_mfma_f32_16x16x32_bf16 v[68:71], v[12:15], v[36:39], v[68:71]
    v_perm_b32 v55, v190, v186, s40
    v_mfma_f32_16x16x32_bf16 v[72:75], v[12:15], v[40:43], v[72:75]
    v_perm_b32 v59, v191, v187, s39
    v_mfma_f32_16x16x32_bf16 v[76:79], v[12:15], v[44:47], v[76:79]
    v_perm_b32 v63, v191, v187, s40
    s_waitcnt vmcnt(23)
    buffer_load_dwordx4 v[184:187], v1, s[20:23], s37 offen offset:2048 nt
    v_mfma_f32_16x16x32_bf16 v[80:83], v[12:15], v[48:51], v[80:83]
    v_perm_b32 v32, v196, v192, s39
    v_mfma_f32_16x16x32_bf16 v[84:87], v[12:15], v[52:55], v[84:87]
    v_perm_b32 v36, v196, v192, s40
    v_mfma_f32_16x16x32_bf16 v[88:91], v[12:15], v[56:59], v[88:91]
    v_perm_b32 v40, v197, v193, s39
    v_mfma_f32_16x16x32_bf16 v[92:95], v[12:15], v[60:63], v[92:95]
    v_perm_b32 v44, v197, v193, s40
    s_waitcnt vmcnt(23)
    buffer_load_dwordx4 v[188:191], v1, s[20:23], s37 offen offset:3072 nt
    s_add_u32 s37, s37, 4096
    v_perm_b32 v48, v198, v194, s39
    v_perm_b32 v52, v198, v194, s40
    v_perm_b32 v56, v199, v195, s39
    v_perm_b32 v60, v199, v195, s40
    s_waitcnt vmcnt(23)
    buffer_load_dwordx4 v[192:195], v1, s[20:23], s36 offen nt
    v_perm_b32 v33, v204, v200, s39
    v_perm_b32 v37, v204, v200, s40
    v_perm_b32 v41, v205, v201, s39
    v_perm_b32 v45, v205, v201, s40
    s_waitcnt vmcnt(23)
    buffer_load_dwordx4 v[196:199], v1, s[20:23], s36 offen offset:1024 nt
    v_perm_b32 v49, v206, v202, s39
    v_perm_b32 v53, v206, v202, s40
    v_perm_b32 v57, v207, v203, s39
    v_perm_b32 v61, v207, v203, s40
    s_waitcnt lgkmcnt(0)
    v_perm_b32 v12, v18, v16, s39
    v_perm_b32 v14, v19, v17, s39
    v_perm_b32 v13, v18, v16, s40
    v_perm_b32 v15, v19, v17, s40
    v_permlane32_swap_b32 v12, v14
    s_and_b32 s41, s38, 1
    s_cmp_eq_u32 s41, 1
    s_cselect_b32 s41, 288, 32
    v_add_u32 v2, s41, v2
    v_permlane32_swap_b32 v13, v15
    s_cmp_eq_u32 s38, 29
    s_cbranch_scc0 L_v1_3_nw
    v_mov_b32 v2, v4
L_v1_3_nw:
    s_cmp_eq_u32 s38, 1
    s_cbranch_scc0 L_v1_3_nx
    v_add_u32 v2, 8192, v4
L_v1_3_nx:
    ds_read_b128 v[16:19], v2
    s_waitcnt vmcnt(23)
    buffer_load_dwordx4 v[200:203], v1, s[20:23], s36 offen offset:2048 nt
    v_perm_b32 v34, v212, v208, s39
    v_perm_b32 v38, v212, v208, s40
    v_perm_b32 v42, v213, v209, s39
    v_perm_b32 v46, v213, v209, s40
    v_permlane16_swap_b32 v12, v13
    v_permlane16_swap_b32 v14, v15
    s_waitcnt vmcnt(23)
    buffer_load_dwordx4 v[204:207], v1, s[20:23], s36 offen offset:3072 nt
    s_add_u32 s36, s36, 4096
    s_and_b32 s41, s36, 32767
    s_cmp_eq_u32 s41, 0
    s_cselect_b32 s41, 32768, 0
    s_add_u32 s36, s36, s41
    v_perm_b32 v50, v214, v210, s39
    v_perm_b32 v54, v214, v210, s40
    v_perm_b32 v58, v215, v211, s39
    v_perm_b32 v62, v215, v211, s40
    s_waitcnt vmcnt(23)
    buffer_load_dwordx4 v[208:211], v1, s[20:23], s37 offen nt
    v_perm_b32 v35, v220, v216, s39
    v_perm_b32 v39, v220, v216, s40
    v_perm_b32 v43, v221, v217, s39
    v_perm_b32 v47, v221, v217, s40
    s_waitcnt vmcnt(23)
    buffer_load_dwordx4 v[212:215], v1, s[20:23], s37 offen offset:1024 nt
    v_mfma_f32_16x16x32_bf16 v[64:67], v[12:15], v[32:35], v[64:67]
    v_perm_b32 v51, v222, v218, s39
    v_mfma_f32_16x16x32_bf16 v[68:71], v[12:15], v[36:39], v[68:71]
    v_perm_b32 v55, v222, v218, s40
    v_mfma_f32_16x16x32_bf16 v[72:75], v[12:15], v[40:43], v[72:75]
    v_perm_b32 v59, v223, v219, s39
    v_mfma_f32_16x16x32_bf16 v[76:79], v[12:15], v[44:47], v[76:79]
    v_perm_b32 v63, v223, v219, s40
L_v_next:
    s_sub_u32 s38, s38, 1
    s_cmp_lg_u32 s38, s45
    s_cbranch_scc1 L_v
    s_cmp_eq_u32 s45, 1
    s_cbranch_scc1 L_tail
    s_mov_b32 s45, 1
    s_mov_b32 s38, 32
    s_waitcnt vmcnt(21)
    buffer_load_dwordx4 v[216:219], v1, s[20:23], s37 offen offset:2048 nt
    v_mfma_f32_16x16x32_bf16 v[80:83], v[12:15], v[48:51], v[80:83]
    v_perm_b32 v32, v100, v96, s39
    v_mfma_f32_16x16x32_bf16 v[84:87], v[12:15], v[52:55], v[84:87]
    v_perm_b32 v36, v100, v96, s40
    v_mfma_f32_16x16x32_bf16 v[88:91], v[12:15], v[56:59], v[88:91]
    v_perm_b32 v40, v101, v97, s39
    v_mfma_f32_16x16x32_bf16 v[92:95], v[12:15], v[60:63], v[92:95]
    v_perm_b32 v44, v101, v97, s40
    s_waitcnt vmcnt(21)
    buffer_load_dwordx4 v[220:223], v1, s[20:23], s37 offen offset:3072 nt
    s_add_u32 s37, s37, 4096
    s_and_b32 s41, s37, 32767
    s_cmp_eq_u32 s41, 0
    s_cselect_b32 s41, 32768, 0
    s_add_u32 s37, s37, s41
    v_perm_b32 v48, v102, v98, s39
    v_perm_b32 v52, v102, v98, s40
    v_perm_b32 v56, v103, v99, s39
    v_perm_b32 v60, v103, v99, s40
    v_cvt_pk_bf16_f32 v240, v64, v65
    v_cvt_pk_bf16_f32 v241, v66, v67
    v_cvt_pk_bf16_f32 v242, v68, v69
    v_cvt_pk_bf16_f32 v243, v70, v71
    v_cvt_pk_bf16_f32 v244, v72, v73
    v_cvt_pk_bf16_f32 v245, v74, v75
    s_waitcnt vmcnt(21)
    buffer_load_dwordx4 v[96:99], v1, s[20:23], s36 offen nt
    v_perm_b32 v33, v108, v104, s39
    v_perm_b32 v37, v108, v104, s40
    v_perm_b32 v41, v109, v105, s39
    v_perm_b32 v45, v109, v105, s40
    v_cvt_pk_bf16_f32 v246, v76, v77
    v_cvt_pk_bf16_f32 v247, v78, v79
    v_cvt_pk_bf16_f32 v248, v80, v81
    v_cvt_pk_bf16_f32 v249, v82, v83
    v_cvt_pk_bf16_f32 v250, v84, v85
    v_cvt_pk_bf16_f32 v251, v86, v87
    s_waitcnt vmcnt(21)
    buffer_load_dwordx4 v[100:103], v1, s[20:23], s36 offen offset:1024 nt
    v_perm_b32 v49, v110, v106, s39
    v_perm_b32 v53, v110, v106, s40
    v_perm_b32 v57, v111, v107, s39
    v_perm_b32 v61, v111, v107, s40
    s_waitcnt lgkmcnt(0)
    v_perm_b32 v12, v18, v16, s39
    v_perm_b32 v14, v19, v17, s39
    v_perm_b32 v13, v18, v16, s40
    v_perm_b32 v15, v19, v17, s40
    v_permlane32_swap_b32 v12, v14
    v_add_u32 v2, 32, v2
    v_permlane32_swap_b32 v13, v15
    ds_read_b128 v[16:19], v2
    v_cvt_pk_bf16_f32 v252, v88, v89
    v_cvt_pk_bf16_f32 v253, v90, v91
    v_cvt_pk_bf16_f32 v254, v92, v93
    v_cvt_pk_bf16_f32 v255, v94, v95
    s_waitcnt vmcnt(21)
    buffer_load_dwordx4 v[104:107], v1, s[20:23], s36 offen offset:2048 nt
    v_perm_b32 v34, v116, v112, s39
    v_perm_b32 v38, v116, v112, s40
    v_perm_b32 v42, v117, v113, s39
    v_perm_b32 v46, v117, v113, s40
    v_permlane16_swap_b32 v12, v13
    v_permlane16_swap_b32 v14, v15
    v_mfma_f32_16x16x16_bf16 v[224:227], v[6:7], v[240:241], 0
    v_mfma_f32_16x16x16_bf16 v[228:231], v[6:7], v[242:243], 0
    s_waitcnt vmcnt(21)
    buffer_load_dwordx4 v[108:111], v1, s[20:23], s36 offen offset:3072 nt
    s_add_u32 s36, s36, 4096
    v_perm_b32 v50, v118, v114, s39
    v_perm_b32 v54, v118, v114, s40
    v_perm_b32 v58, v119, v115, s39
    v_perm_b32 v62, v119, v115, s40
    v_mfma_f32_16x16x16_bf16 v[232:235], v[6:7], v[244:245], 0
    v_mfma_f32_16x16x16_bf16 v[236:239], v[6:7], v[246:247], 0
    s_waitcnt vmcnt(21)
    buffer_load_dwordx4 v[112:115], v1, s[20:23], s37 offen nt
    v_perm_b32 v35, v124, v120, s39
    v_perm_b32 v39, v124, v120, s40
    v_perm_b32 v43, v125, v121, s39
    v_perm_b32 v47, v125, v121, s40
    s_waitcnt vmcnt(21)
    buffer_load_dwordx4 v[116:119], v1, s[20:23], s37 offen offset:1024 nt
    v_mfma_f32_16x16x32_bf16 v[64:67], v[12:15], v[32:35], 0
    v_perm_b32 v51, v126, v122, s39
    v_mfma_f32_16x16x32_bf16 v[68:71], v[12:15], v[36:39], 0
    v_perm_b32 v55, v126, v122, s40
    v_mfma_f32_16x16x32_bf16 v[72:75], v[12:15], v[40:43], 0
    v_perm_b32 v59, v127, v123, s39
    v_mfma_f32_16x16x32_bf16 v[76:79], v[12:15], v[44:47], 0
    v_perm_b32 v63, v127, v123, s40
    s_waitcnt vmcnt(21)
    buffer_load_dwordx4 v[120:123], v1, s[20:23], s37 offen offset:2048 nt
    v_mfma_f32_16x16x32_bf16 v[80:83], v[12:15], v[48:51], 0
    v_perm_b32 v32, v132, v128, s39
    v_mfma_f32_16x16x32_bf16 v[84:87], v[12:15], v[52:55], 0
    v_perm_b32 v36, v132, v128, s40
    v_mfma_f32_16x16x32_bf16 v[88:91], v[12:15], v[56:59], 0
    v_perm_b32 v40, v133, v129, s39
    v_mfma_f32_16x16x32_bf16 v[92:95], v[12:15], v[60:63], 0
    v_perm_b32 v44, v133, v129, s40
    s_add_u32 s52, s52, 1
    v_mov_b32 v11, s52
    buffer_store_byte v11, off, s[60:63], s64
    buffer_load_ubyte v5, v0, s[60:63], 0 offen sc1
    s_waitcnt vmcnt(21)
    buffer_load_dwordx4 v[124:127], v1, s[20:23], s37 offen offset:3072 nt
    s_add_u32 s37, s37, 4096
    v_perm_b32 v48, v134, v130, s39
    v_perm_b32 v52, v134, v130, s40
    v_perm_b32 v56, v135, v131, s39
    v_perm_b32 v60, v135, v131, s40
    v_cvt_pk_bf16_f32 v24, v224, v228
    v_cvt_pk_bf16_f32 v25, v232, v236
    s_waitcnt vmcnt(21)
    buffer_load_dwordx4 v[128:131], v1, s[20:23], s36 offen nt
    v_perm_b32 v33, v140, v136, s39
    v_perm_b32 v37, v140, v136, s40
    v_perm_b32 v41, v141, v137, s39
    v_perm_b32 v45, v141, v137, s40
    v_mfma_f32_16x16x16_bf16 v[224:227], v[6:7], v[248:249], 0
    v_mfma_f32_16x16x16_bf16 v[228:231], v[6:7], v[250:251], 0
    s_waitcnt vmcnt(21)
    buffer_load_dwordx4 v[132:135], v1, s[20:23], s36 offen offset:1024 nt
    v_perm_b32 v49, v142, v138, s39
    v_perm_b32 v53, v142, v138, s40
    v_perm_b32 v57, v143, v139, s39
    v_perm_b32 v61, v143, v139, s40
    s_waitcnt lgkmcnt(0)
    v_perm_b32 v12, v18, v16, s39
    v_perm_b32 v14, v19, v17, s39
    v_perm_b32 v13, v18, v16, s40
    v_perm_b32 v15, v19, v17, s40
    v_permlane32_swap_b32 v12, v14
    v_add_u32 v2, 32, v2
    v_permlane32_swap_b32 v13, v15
    ds_read_b128 v[16:19], v2
    v_mfma_f32_16x16x16_bf16 v[232:235], v[6:7], v[252:253], 0
    v_mfma_f32_16x16x16_bf16 v[236:239], v[6:7], v[254:255], 0
    s_waitcnt vmcnt(21)
    buffer_load_dwordx4 v[136:139], v1, s[20:23], s36 offen offset:2048 nt
    v_perm_b32 v34, v148, v144, s39
    v_perm_b32 v38, v148, v144, s40
    v_perm_b32 v42, v149, v145, s39
    v_perm_b32 v46, v149, v145, s40
    v_permlane16_swap_b32 v12, v13
    v_permlane16_swap_b32 v14, v15
    s_waitcnt vmcnt(21)
    buffer_load_dwordx4 v[140:143], v1, s[20:23], s36 offen offset:3072 nt
    s_add_u32 s36, s36, 4096
    v_perm_b32 v50, v150, v146, s39
    v_perm_b32 v54, v150, v146, s40
    v_perm_b32 v58, v151, v147, s39
    v_perm_b32 v62, v151, v147, s40
    s_waitcnt vmcnt(21)
    buffer_load_dwordx4 v[144:147], v1, s[20:23], s37 offen nt
    v_perm_b32 v35, v156, v152, s39
    v_perm_b32 v39, v156, v152, s40
    v_perm_b32 v43, v157, v153, s39
    v_perm_b32 v47, v157, v153, s40
    v_cvt_pk_bf16_f32 v26, v224, v228
    v_cvt_pk_bf16_f32 v27, v232, v236
    buffer_store_dwordx4 v[24:27], v1, s[28:31], 0 offen
    s_waitcnt vmcnt(21)
    buffer_load_dwordx4 v[148:151], v1, s[20:23], s37 offen offset:1024 nt
    v_mfma_f32_16x16x32_bf16 v[64:67], v[12:15], v[32:35], v[64:67]
    v_perm_b32 v51, v158, v154, s39
    v_mfma_f32_16x16x32_bf16 v[68:71], v[12:15], v[36:39], v[68:71]
    v_perm_b32 v55, v158, v154, s40
    v_mfma_f32_16x16x32_bf16 v[72:75], v[12:15], v[40:43], v[72:75]
    v_perm_b32 v59, v159, v155, s39
    v_mfma_f32_16x16x32_bf16 v[76:79], v[12:15], v[44:47], v[76:79]
    v_perm_b32 v63, v159, v155, s40
    s_waitcnt vmcnt(21)
    buffer_load_dwordx4 v[152:155], v1, s[20:23], s37 offen offset:2048 nt
    v_mfma_f32_16x16x32_bf16 v[80:83], v[12:15], v[48:51], v[80:83]
    v_perm_b32 v32, v164, v160, s39
    v_mfma_f32_16x16x32_bf16 v[84:87], v[12:15], v[52:55], v[84:87]
    v_perm_b32 v36, v164, v160, s40
    v_mfma_f32_16x16x32_bf16 v[88:91], v[12:15], v[56:59], v[88:91]
    v_perm_b32 v40, v165, v161, s39
    v_mfma_f32_16x16x32_bf16 v[92:95], v[12:15], v[60:63], v[92:95]
    v_perm_b32 v44, v165, v161, s40
    s_waitcnt vmcnt(21)
    buffer_load_dwordx4 v[156:159], v1, s[20:23], s37 offen offset:3072 nt
    s_add_u32 s37, s37, 4096
    v_perm_b32 v48, v166, v162, s39
    v_perm_b32 v52, v166, v162, s40
    v_perm_b32 v56, v167, v163, s39
    v_perm_b32 v60, v167, v163, s40
    s_waitcnt vmcnt(21)
    buffer_load_dwordx4 v[160:163], v1, s[20:23], s36 offen nt
    v_perm_b32 v33, v172, v168, s39
    v_perm_b32 v37, v172, v168, s40
    v_perm_b32 v41, v173, v169, s39
    v_perm_b32 v45, v173, v169, s40
    s_waitcnt vmcnt(21)
    buffer_load_dwordx4 v[164:167], v1, s[20:23], s36 offen offset:1024 nt
    v_perm_b32 v49, v174, v170, s39
    v_perm_b32 v53, v174, v170, s40
    v_perm_b32 v57, v175, v171, s39
    v_perm_b32 v61, v175, v171, s40
    s_waitcnt lgkmcnt(0)
    v_perm_b32 v12, v18, v16, s39
    v_perm_b32 v14, v19, v17, s39
    v_perm_b32 v13, v18, v16, s40
    v_perm_b32 v15, v19, v17, s40
    v_permlane32_swap_b32 v12, v14
    v_add_u32 v2, 32, v2
    v_permlane32_swap_b32 v13, v15
    ds_read_b128 v[16:19], v2
    s_waitcnt vmcnt(21)
    buffer_load_dwordx4 v[168:171], v1, s[20:23], s36 offen offset:2048 nt
    v_perm_b32 v34, v180, v176, s39
    v_perm_b32 v38, v180, v176, s40
    v_perm_b32 v42, v181, v177, s39
    v_perm_b32 v46, v181, v177, s40
    v_permlane16_swap_b32 v12, v13
    v_permlane16_swap_b32 v14, v15
    s_waitcnt vmcnt(21)
    buffer_load_dwordx4 v[172:175], v1, s[20:23], s36 offen offset:3072 nt
    s_add_u32 s36, s36, 4096
    v_perm_b32 v50, v182, v178, s39
    v_perm_b32 v54, v182, v178, s40
    v_perm_b32 v58, v183, v179, s39
    v_perm_b32 v62, v183, v179, s40
    s_waitcnt vmcnt(21)
    buffer_load_dwordx4 v[176:179], v1, s[20:23], s37 offen nt
    v_perm_b32 v35, v188, v184, s39
    v_perm_b32 v39, v188, v184, s40
    v_perm_b32 v43, v189, v185, s39
    v_perm_b32 v47, v189, v185, s40
    s_waitcnt vmcnt(21)
    buffer_load_dwordx4 v[180:183], v1, s[20:23], s37 offen offset:1024 nt
    v_mfma_f32_16x16x32_bf16 v[64:67], v[12:15], v[32:35], v[64:67]
    v_perm_b32 v51, v190, v186, s39
    v_mfma_f32_16x16x32_bf16 v[68:71], v[12:15], v[36:39], v[68:71]
    v_perm_b32 v55, v190, v186, s40
    v_mfma_f32_16x16x32_bf16 v[72:75], v[12:15], v[40:43], v[72:75]
    v_perm_b32 v59, v191, v187, s39
    v_mfma_f32_16x16x32_bf16 v[76:79], v[12:15], v[44:47], v[76:79]
    v_perm_b32 v63, v191, v187, s40
    s_waitcnt vmcnt(21)
    buffer_load_dwordx4 v[184:187], v1, s[20:23], s37 offen offset:2048 nt
    v_mfma_f32_16x16x32_bf16 v[80:83], v[12:15], v[48:51], v[80:83]
    v_perm_b32 v32, v196, v192, s39
    v_mfma_f32_16x16x32_bf16 v[84:87], v[12:15], v[52:55], v[84:87]
    v_perm_b32 v36, v196, v192, s40
    v_mfma_f32_16x16x32_bf16 v[88:91], v[12:15], v[56:59], v[88:91]
    v_perm_b32 v40, v197, v193, s39
    v_mfma_f32_16x16x32_bf16 v[92:95], v[12:15], v[60:63], v[92:95]
    v_perm_b32 v44, v197, v193, s40
    s_waitcnt vmcnt(21)
    buffer_load_dwordx4 v[188:191], v1, s[20:23], s37 offen offset:3072 nt
    s_add_u32 s37, s37, 4096
    v_perm_b32 v48, v198, v194, s39
    v_perm_b32 v52, v198, v194, s40
    v_perm_b32 v56, v199, v195, s39
    v_perm_b32 v60, v199, v195, s40
    s_waitcnt vmcnt(21)
    buffer_load_dwordx4 v[192:195], v1, s[20:23], s36 offen nt
    v_perm_b32 v33, v204, v200, s39
    v_perm_b32 v37, v204, v200, s40
    v_perm_b32 v41, v205, v201, s39
    v_perm_b32 v45, v205, v201, s40
    s_waitcnt vmcnt(21)
    buffer_load_dwordx4 v[196:199], v1, s[20:23], s36 offen offset:1024 nt
    v_perm_b32 v49, v206, v202, s39
    v_perm_b32 v53, v206, v202, s40
    v_perm_b32 v57, v207, v203, s39
    v_perm_b32 v61, v207, v203, s40
    s_waitcnt lgkmcnt(0)
    v_perm_b32 v12, v18, v16, s39
    v_perm_b32 v14, v19, v17, s39
    v_perm_b32 v13, v18, v16, s40
    v_perm_b32 v15, v19, v17, s40
    v_permlane32_swap_b32 v12, v14
    s_and_b32 s41, s38, 1
    s_cmp_eq_u32 s41, 1
    s_cselect_b32 s41, 288, 32
    v_add_u32 v2, s41, v2
    v_permlane32_swap_b32 v13, v15
    ds_read_b128 v[16:19], v2
    s_waitcnt vmcnt(21)
    buffer_load_dwordx4 v[200:203], v1, s[20:23], s36 offen offset:2048 nt
    v_perm_b32 v34, v212, v208, s39
    v_perm_b32 v38, v212, v208, s40
    v_perm_b32 v42, v213, v209, s39
    v_perm_b32 v46, v213, v209, s40
    v_permlane16_swap_b32 v12, v13
    v_permlane16_swap_b32 v14, v15
    s_waitcnt vmcnt(21)
    buffer_load_dwordx4 v[204:207], v1, s[20:23], s36 offen offset:3072 nt
    s_add_u32 s36, s36, 4096
    s_and_b32 s41, s36, 32767
    s_cmp_eq_u32 s41, 0
    s_cselect_b32 s41, 32768, 0
    s_add_u32 s36, s36, s41
    v_perm_b32 v50, v214, v210, s39
    v_perm_b32 v54, v214, v210, s40
    v_perm_b32 v58, v215, v211, s39
    v_perm_b32 v62, v215, v211, s40
    s_waitcnt vmcnt(21)
    buffer_load_dwordx4 v[208:211], v1, s[20:23], s37 offen nt
    v_perm_b32 v35, v220, v216, s39
    v_perm_b32 v39, v220, v216, s40
    v_perm_b32 v43, v221, v217, s39
    v_perm_b32 v47, v221, v217, s40
    s_waitcnt vmcnt(21)
    buffer_load_dwordx4 v[212:215], v1, s[20:23], s37 offen offset:1024 nt
    v_mfma_f32_16x16x32_bf16 v[64:67], v[12:15], v[32:35], v[64:67]
    v_perm_b32 v51, v222, v218, s39
    v_mfma_f32_16x16x32_bf16 v[68:71], v[12:15], v[36:39], v[68:71]
    v_perm_b32 v55, v222, v218, s40
    v_mfma_f32_16x16x32_bf16 v[72:75], v[12:15], v[40:43], v[72:75]
    v_perm_b32 v59, v223, v219, s39
    v_mfma_f32_16x16x32_bf16 v[76:79], v[12:15], v[44:47], v[76:79]
    v_perm_b32 v63, v223, v219, s40
    s_branch L_v_next
L_tail:
    s_waitcnt vmcnt(23)
    buffer_load_dwordx4 v[216:219], v1, s[20:23], s37 offen offset:2048 nt
    v_mfma_f32_16x16x32_bf16 v[80:83], v[12:15], v[48:51], v[80:83]
    v_perm_b32 v32, v100, v96, s39
    v_mfma_f32_16x16x32_bf16 v[84:87], v[12:15], v[52:55], v[84:87]
    v_perm_b32 v36, v100, v96, s40
    v_mfma_f32_16x16x32_bf16 v[88:91], v[12:15], v[56:59], v[88:91]
    v_perm_b32 v40, v101, v97, s39
    v_mfma_f32_16x16x32_bf16 v[92:95], v[12:15], v[60:63], v[92:95]
    v_perm_b32 v44, v101, v97, s40
    s_waitcnt vmcnt(23)
    buffer_load_dwordx4 v[220:223], v1, s[20:23], s37 offen offset:3072 nt
    s_add_u32 s37, s37, 4096
    s_and_b32 s41, s37, 32767
    s_cmp_eq_u32 s41, 0
    s_cselect_b32 s41, 32768, 0
    s_add_u32 s37, s37, s41
    v_perm_b32 v48, v102, v98, s39
    v_perm_b32 v52, v102, v98, s40
    v_perm_b32 v56, v103, v99, s39
    v_perm_b32 v60, v103, v99, s40
    v_perm_b32 v33, v108, v104, s39
    v_perm_b32 v37, v108, v104, s40
    v_perm_b32 v41, v109, v105, s39
    v_perm_b32 v45, v109, v105, s40
    v_perm_b32 v49, v110, v106, s39
    v_perm_b32 v53, v110, v106, s40
    v_perm_b32 v57, v111, v107, s39
    v_perm_b32 v61, v111, v107, s40
    s_waitcnt lgkmcnt(0)
    v_perm_b32 v12, v18, v16, s39
    v_perm_b32 v14, v19, v17, s39
    v_perm_b32 v13, v18, v16, s40
    v_perm_b32 v15, v19, v17, s40
    v_permlane32_swap_b32 v12, v14
    v_add_u32 v2, 32, v2
    v_permlane32_swap_b32 v13, v15
    ds_read_b128 v[16:19], v2
    v_perm_b32 v34, v116, v112, s39
    v_perm_b32 v38, v116, v112, s40
    v_perm_b32 v42, v117, v113, s39
    v_perm_b32 v46, v117, v113, s40
    v_permlane16_swap_b32 v12, v13
    v_permlane16_swap_b32 v14, v15
    v_perm_b32 v50, v118, v114, s39
    v_perm_b32 v54, v118, v114, s40
    v_perm_b32 v58, v119, v115, s39
    v_perm_b32 v62, v119, v115, s40
    v_perm_b32 v35, v124, v120, s39
    v_perm_b32 v39, v124, v120, s40
    v_perm_b32 v43, v125, v121, s39
    v_perm_b32 v47, v125, v121, s40
    v_mfma_f32_16x16x32_bf16 v[64:67], v[12:15], v[32:35], v[64:67]
    v_perm_b32 v51, v126, v122, s39
    v_mfma_f32_16x16x32_bf16 v[68:71], v[12:15], v[36:39], v[68:71]
    v_perm_b32 v55, v126, v122, s40
    v_mfma_f32_16x16x32_bf16 v[72:75], v[12:15], v[40:43], v[72:75]
    v_perm_b32 v59, v127, v123, s39
    v_mfma_f32_16x16x32_bf16 v[76:79], v[12:15], v[44:47], v[76:79]
    v_perm_b32 v63, v127, v123, s40
    s_waitcnt vmcnt(22)
    v_mfma_f32_16x16x32_bf16 v[80:83], v[12:15], v[48:51], v[80:83]
    v_perm_b32 v32, v132, v128, s39
    v_mfma_f32_16x16x32_bf16 v[84:87], v[12:15], v[52:55], v[84:87]
    v_perm_b32 v36, v132, v128, s40
    v_mfma_f32_16x16x32_bf16 v[88:91], v[12:15], v[56:59], v[88:91]
    v_perm_b32 v40, v133, v129, s39
    v_mfma_f32_16x16x32_bf16 v[92:95], v[12:15], v[60:63], v[92:95]
    v_perm_b32 v44, v133, v129, s40
    v_perm_b32 v48, v134, v130, s39
    v_perm_b32 v52, v134, v130, s40
    v_perm_b32 v56, v135, v131, s39
    v_perm_b32 v60, v135, v131, s40
    s_waitcnt vmcnt(20)
    v_perm_b32 v33, v140, v136, s39
    v_perm_b32 v37, v140, v136, s40
    v_perm_b32 v41, v141, v137, s39
    v_perm_b32 v45, v141, v137, s40
    v_perm_b32 v49, v142, v138, s39
    v_perm_b32 v53, v142, v138, s40
    v_perm_b32 v57, v143, v139, s39
    v_perm_b32 v61, v143, v139, s40
    s_waitcnt lgkmcnt(0)
    v_perm_b32 v12, v18, v16, s39
    v_perm_b32 v14, v19, v17, s39
    v_perm_b32 v13, v18, v16, s40
    v_perm_b32 v15, v19, v17, s40
    v_permlane32_swap_b32 v12, v14
    v_add_u32 v2, 32, v2
    v_permlane32_swap_b32 v13, v15
    ds_read_b128 v[16:19], v2
    s_waitcnt vmcnt(18)
    v_perm_b32 v34, v148, v144, s39
    v_perm_b32 v38, v148, v144, s40
    v_perm_b32 v42, v149, v145, s39
    v_perm_b32 v46, v149, v145, s40
    v_permlane16_swap_b32 v12, v13
    v_permlane16_swap_b32 v14, v15
    v_perm_b32 v50, v150, v146, s39
    v_perm_b32 v54, v150, v146, s40
    v_perm_b32 v58, v151, v147, s39
    v_perm_b32 v62, v151, v147, s40
    s_waitcnt vmcnt(16)
    v_perm_b32 v35, v156, v152, s39
    v_perm_b32 v39, v156, v152, s40
    v_perm_b32 v43, v157, v153, s39
    v_perm_b32 v47, v157, v153, s40
    v_mfma_f32_16x16x32_bf16 v[64:67], v[12:15], v[32:35], v[64:67]
    v_perm_b32 v51, v158, v154, s39
    v_mfma_f32_16x16x32_bf16 v[68:71], v[12:15], v[36:39], v[68:71]
    v_perm_b32 v55, v158, v154, s40
    v_mfma_f32_16x16x32_bf16 v[72:75], v[12:15], v[40:43], v[72:75]
    v_perm_b32 v59, v159, v155, s39
    v_mfma_f32_16x16x32_bf16 v[76:79], v[12:15], v[44:47], v[76:79]
    v_perm_b32 v63, v159, v155, s40
    s_waitcnt vmcnt(14)
    v_mfma_f32_16x16x32_bf16 v[80:83], v[12:15], v[48:51], v[80:83]
    v_perm_b32 v32, v164, v160, s39
    v_mfma_f32_16x16x32_bf16 v[84:87], v[12:15], v[52:55], v[84:87]
    v_perm_b32 v36, v164, v160, s40
    v_mfma_f32_16x16x32_bf16 v[88:91], v[12:15], v[56:59], v[88:91]
    v_perm_b32 v40, v165, v161, s39
    v_mfma_f32_16x16x32_bf16 v[92:95], v[12:15], v[60:63], v[92:95]
    v_perm_b32 v44, v165, v161, s40
    v_perm_b32 v48, v166, v162, s39
    v_perm_b32 v52, v166, v162, s40
    v_perm_b32 v56, v167, v163, s39
    v_perm_b32 v60, v167, v163, s40
    s_waitcnt vmcnt(12)
    v_perm_b32 v33, v172, v168, s39
    v_perm_b32 v37, v172, v168, s40
    v_perm_b32 v41, v173, v169, s39
    v_perm_b32 v45, v173, v169, s40
    v_perm_b32 v49, v174, v170, s39
    v_perm_b32 v53, v174, v170, s40
    v_perm_b32 v57, v175, v171, s39
    v_perm_b32 v61, v175, v171, s40
    s_waitcnt lgkmcnt(0)
    v_perm_b32 v12, v18, v16, s39
    v_perm_b32 v14, v19, v17, s39
    v_perm_b32 v13, v18, v16, s40
    v_perm_b32 v15, v19, v17, s40
    v_permlane32_swap_b32 v12, v14
    v_add_u32 v2, 32, v2
    v_permlane32_swap_b32 v13, v15
    ds_read_b128 v[16:19], v2
    s_waitcnt vmcnt(10)
    v_perm_b32 v34, v180, v176, s39
    v_perm_b32 v38, v180, v176, s40
    v_perm_b32 v42, v181, v177, s39
    v_perm_b32 v46, v181, v177, s40
    v_permlane16_swap_b32 v12, v13
    v_permlane16_swap_b32 v14, v15
    v_perm_b32 v50, v182, v178, s39
    v_perm_b32 v54, v182, v178, s40
    v_perm_b32 v58, v183, v179, s39
    v_perm_b32 v62, v183, v179, s40
    s_waitcnt vmcnt(8)
    v_perm_b32 v35, v188, v184, s39
    v_perm_b32 v39, v188, v184, s40
    v_perm_b32 v43, v189, v185, s39
    v_perm_b32 v47, v189, v185, s40
    v_mfma_f32_16x16x32_bf16 v[64:67], v[12:15], v[32:35], v[64:67]
    v_perm_b32 v51, v190, v186, s39
    v_mfma_f32_16x16x32_bf16 v[68:71], v[12:15], v[36:39], v[68:71]
    v_perm_b32 v55, v190, v186, s40
    v_mfma_f32_16x16x32_bf16 v[72:75], v[12:15], v[40:43], v[72:75]
    v_perm_b32 v59, v191, v187, s39
    v_mfma_f32_16x16x32_bf16 v[76:79], v[12:15], v[44:47], v[76:79]
    v_perm_b32 v63, v191, v187, s40
    s_waitcnt vmcnt(6)
    v_mfma_f32_16x16x32_bf16 v[80:83], v[12:15], v[48:51], v[80:83]
    v_perm_b32 v32, v196, v192, s39
    v_mfma_f32_16x16x32_bf16 v[84:87], v[12:15], v[52:55], v[84:87]
    v_perm_b32 v36, v196, v192, s40
    v_mfma_f32_16x16x32_bf16 v[88:91], v[12:15], v[56:59], v[88:91]
    v_perm_b32 v40, v197, v193, s39
    v_mfma_f32_16x16x32_bf16 v[92:95], v[12:15], v[60:63], v[92:95]
    v_perm_b32 v44, v197, v193, s40
    v_perm_b32 v48, v198, v194, s39
    v_perm_b32 v52, v198, v194, s40
    v_perm_b32 v56, v199, v195, s39
    v_perm_b32 v60, v199, v195, s40
    s_waitcnt vmcnt(4)
    v_perm_b32 v33, v204, v200, s39
    v_perm_b32 v37, v204, v200, s40
    v_perm_b32 v41, v205, v201, s39
    v_perm_b32 v45, v205, v201, s40
    v_perm_b32 v49, v206, v202, s39
    v_perm_b32 v53, v206, v202, s40
    v_perm_b32 v57, v207, v203, s39
    v_perm_b32 v61, v207, v203, s40
    s_waitcnt lgkmcnt(0)
    v_perm_b32 v12, v18, v16, s39
    v_perm_b32 v14, v19, v17, s39
    v_perm_b32 v13, v18, v16, s40
    v_perm_b32 v15, v19, v17, s40
    v_permlane32_swap_b32 v12, v14
    s_nop 0
    v_permlane32_swap_b32 v13, v15
    s_nop 0
    s_waitcnt vmcnt(2)
    v_perm_b32 v34, v212, v208, s39
    v_perm_b32 v38, v212, v208, s40
    v_perm_b32 v42, v213, v209, s39
    v_perm_b32 v46, v213, v209, s40
    v_permlane16_swap_b32 v12, v13
    v_permlane16_swap_b32 v14, v15
    v_perm_b32 v50, v214, v210, s39
    v_perm_b32 v54, v214, v210, s40
    v_perm_b32 v58, v215, v211, s39
    v_perm_b32 v62, v215, v211, s40
    s_waitcnt vmcnt(0)
    v_perm_b32 v35, v220, v216, s39
    v_perm_b32 v39, v220, v216, s40
    v_perm_b32 v43, v221, v217, s39
    v_perm_b32 v47, v221, v217, s40
    v_mfma_f32_16x16x32_bf16 v[64:67], v[12:15], v[32:35], v[64:67]
    v_perm_b32 v51, v222, v218, s39
    v_mfma_f32_16x16x32_bf16 v[68:71], v[12:15], v[36:39], v[68:71]
    v_perm_b32 v55, v222, v218, s40
    v_mfma_f32_16x16x32_bf16 v[72:75], v[12:15], v[40:43], v[72:75]
    v_perm_b32 v59, v223, v219, s39
    v_mfma_f32_16x16x32_bf16 v[76:79], v[12:15], v[44:47], v[76:79]
    v_perm_b32 v63, v223, v219, s40
    s_nop 1
    v_mfma_f32_16x16x32_bf16 v[80:83], v[12:15], v[48:51], v[80:83]
    v_mfma_f32_16x16x32_bf16 v[84:87], v[12:15], v[52:55], v[84:87]
    v_mfma_f32_16x16x32_bf16 v[88:91], v[12:15], v[56:59], v[88:91]
    v_mfma_f32_16x16x32_bf16 v[92:95], v[12:15], v[60:63], v[92:95]
    s_nop 3
    v_cvt_pk_bf16_f32 v64, v64, v65
    v_cvt_pk_bf16_f32 v65, v66, v67
    v_cvt_pk_bf16_f32 v68, v68, v69
    v_cvt_pk_bf16_f32 v69, v70, v71
    v_mfma_f32_16x16x16_bf16 v[32:35], v[8:9], v[64:65], 0
    v_cvt_pk_bf16_f32 v72, v72, v73
    v_cvt_pk_bf16_f32 v73, v74, v75
    v_mfma_f32_16x16x16_bf16 v[36:39], v[8:9], v[68:69], 0
    v_cvt_pk_bf16_f32 v76, v76, v77
    v_cvt_pk_bf16_f32 v77, v78, v79
    v_mfma_f32_16x16x16_bf16 v[40:43], v[8:9], v[72:73], 0
    v_cvt_pk_bf16_f32 v80, v80, v81
    v_cvt_pk_bf16_f32 v81, v82, v83
    v_mfma_f32_16x16x16_bf16 v[44:47], v[8:9], v[76:77], 0
    v_cvt_pk_bf16_f32 v84, v84, v85
    v_cvt_pk_bf16_f32 v85, v86, v87
    v_mfma_f32_16x16x16_bf16 v[48:51], v[8:9], v[80:81], 0
    v_cvt_pk_bf16_f32 v88, v88, v89
    v_cvt_pk_bf16_f32 v89, v90, v91
    v_mfma_f32_16x16x16_bf16 v[52:55], v[8:9], v[84:85], 0
    v_cvt_pk_bf16_f32 v92, v92, v93
    v_cvt_pk_bf16_f32 v93, v94, v95
    v_mfma_f32_16x16x16_bf16 v[56:59], v[8:9], v[88:89], 0
    s_nop 0
    v_mfma_f32_16x16x16_bf16 v[60:63], v[8:9], v[92:93], 0
    s_nop 4
    v_cvt_pk_bf16_f32 v24, v32, v36
    v_cvt_pk_bf16_f32 v25, v40, v44
    v_cvt_pk_bf16_f32 v26, v48, v52
    v_cvt_pk_bf16_f32 v27, v56, v60
    buffer_store_dwordx4 v[24:27], v1, s[28:31], 0 offen offset:1024
L_end:
    s_endpgm
.section .rodata,"a"
.p2align 6
.amdhsa_kernel standalone__low_rank_proj_linformer__sampling_kernel
  .amdhsa_next_free_vgpr 272
  .amdhsa_next_free_sgpr 96
  .amdhsa_accum_offset 256
  .amdhsa_group_segment_fixed_size 0
  .amdhsa_kernarg_size 64
  .amdhsa_user_sgpr_count 2
  .amdhsa_user_sgpr_kernarg_segment_ptr 1
  .amdhsa_system_sgpr_workgroup_id_x 1
  .amdhsa_float_denorm_mode_32 3
.end_amdhsa_kernel
```
